```python
import torch

def _softmax(x, axis=-1):
    return torch.softmax(x, dim=axis)
def _gelu(x):
    return torch.nn.functional.gelu(x, approximate="tanh")
def _silu(x):
    return torch.nn.functional.silu(x)
def _sigmoid(x):
    return torch.sigmoid(x)
def _layernorm(x, axis=-1, eps=1e-5):
    m = x.mean(dim=axis, keepdim=True)
    v = x.var(dim=axis, keepdim=True, unbiased=False)
    return (x - m) / torch.sqrt(v + eps)
def _scatter_add(tgt, idx, src, axis=0):
    return tgt.clone().index_add_(axis, idx, src)
def _segment_sum(src, seg, n):
    out = torch.zeros((n,) + src.shape[1:], dtype=src.dtype)
    return out.index_add_(0, seg, src)
def _pad(x, pw):
    flat = tuple(v for pair in reversed(pw) for v in pair)
    return torch.nn.functional.pad(x, flat)

kernel_name = 'sequential_preLN__gqa_block_cached__glu_gated_glu__decode'

def setup_inputs():

    _w = (lambda a: (lambda t: t.to(torch.bfloat16) if t.is_floating_point() else t)(torch.as_tensor(a)))
    def _A_setup():
        B, Sq, D = 1, 1, 512
        Hq, Hkv, Sk, Dh = 32, 8, 65536, 128
        assert Hq % Hkv == 0, (Hq, Hkv)
        return {
            "x": _w((lambda *s: torch.randn(*s, dtype=torch.bfloat16) * 0.05)(B, Sq, D)),
            "k_cache": _w((lambda *s: torch.randn(*s, dtype=torch.bfloat16) * 3.2)(B, Hkv, Sk, Dh)),
            "v_cache": _w((lambda *s: torch.randn(*s, dtype=torch.bfloat16) * 0.4)(B, Hkv, Sk, Dh)),
            "wq": _w((lambda *s: torch.randn(*s, dtype=torch.bfloat16) * 3.2)(D, Hq * Dh) * (D ** -0.5)),
            "wo": _w((lambda *s: torch.randn(*s, dtype=torch.bfloat16) * 0.4)(Hq * Dh, D) * ((Hq * Dh) ** -0.5)),
        }
    _A_in = _A_setup()

    def _B_setup():
        B, S, D, F = 1, 1, 512, 1792
        return {
            "x": _w((lambda *s: torch.randn(*s, dtype=torch.bfloat16) * 0.05)(B, S, D)),
            "w_gate": _w((lambda *s: torch.randn(*s, dtype=torch.bfloat16) * 0.2)(D, F)),
            "w_up": _w((lambda *s: torch.randn(*s, dtype=torch.bfloat16) * 0.05)(D, F)),
            "w_down": _w((lambda *s: torch.randn(*s, dtype=torch.bfloat16) * 0.05)(F, D)),
        }
    _B_in = _B_setup()

    return {
        "A_x": _A_in["x"],
        "A_k_cache": _A_in["k_cache"],
        "A_v_cache": _A_in["v_cache"],
        "A_wq": _A_in["wq"],
        "A_wo": _A_in["wo"],
        "B_x": _B_in["x"],
        "B_w_gate": _B_in["w_gate"],
        "B_w_up": _B_in["w_up"],
        "B_w_down": _B_in["w_down"],
    }

def reference(A_x, A_k_cache, A_v_cache, A_wq, A_wo, B_x, B_w_gate, B_w_up, B_w_down):
    def _A_ref(x, k_cache, v_cache, wq, wo):
        B, Sq, D = x.shape
        Hq, Dh = 32, 128
        Hkv = k_cache.shape[1]
        rep = Hq // Hkv
        q = (lambda x, *d: x.permute(*d))((x @ wq).reshape(B, Sq, Hq, Dh), 0, 2, 1, 3)
        k = (lambda x, n, axis: torch.repeat_interleave(x, n, dim=axis))(k_cache, rep, axis=1)
        v = (lambda x, n, axis: torch.repeat_interleave(x, n, dim=axis))(v_cache, rep, axis=1)
        scores = torch.einsum("bhqd,bhkd->bhqk", q, k) * (Dh ** -0.5)
        p = _softmax(scores, axis=-1)
        o = torch.einsum("bhqk,bhkd->bhqd", p, v)
        return (lambda x, *d: x.permute(*d))(o, 0, 2, 1, 3).reshape(B, Sq, Hq * Dh) @ wo

    def _B_ref(x, w_gate, w_up, w_down):
        g = torch.einsum("bsd,df->bsf", x, w_gate)
        u = torch.einsum("bsd,df->bsf", x, w_up)
        h = _sigmoid(g) * u
        return torch.einsum("bsf,fd->bsd", h, w_down)

    x = A_x
    h = x + _A_ref(_layernorm(x, axis=-1), A_k_cache, A_v_cache, A_wq, A_wo)
    h2 = h + _B_ref(_layernorm(h, axis=-1), B_w_gate, B_w_up, B_w_down)
    return h2
```

```asm
; @launch grid=(256,1,1) block=(512,1,1) lds=149312
.amdgcn_target "amdgcn-amd-amdhsa--gfx950"
.text
.globl sequential_preLN__gqa_block_cached__glu_gated_glu__decode_kernel
.p2align 8
.type sequential_preLN__gqa_block_cached__glu_gated_glu__decode_kernel,@function
sequential_preLN__gqa_block_cached__glu_gated_glu__decode_kernel:
    s_cmp_ge_u32 s2, 256
    s_cbranch_scc1 L_done
    s_load_dwordx16 s[16:31], s[0:1], 0
    s_load_dwordx8 s[32:39], s[0:1], 64
    v_lshrrev_b32 v1, 6, v0
    s_nop 0
    v_readfirstlane_b32 s3, v1
    v_and_b32 v1, 63, v0
    v_lshlrev_b32 v2, 4, v1
    v_lshrrev_b32 v3, 4, v1
    v_lshlrev_b32 v3, 4, v3
    s_setprio 3
    s_lshr_b32 s4, s2, 5
    s_and_b32 s5, s2, 31
    s_lshl_b32 s6, s5, 3
    s_add_u32 s6, s6, s3
    s_lshl_b32 s7, s4, 24
    s_lshl_b32 s8, s6, 13
    s_lshl_b32 s60, s3, 14
    s_mul_i32 s67, s4, 827392
    s_sub_u32 s10, s5, s4
    s_and_b32 s10, s10, 31
    s_sub_u32 s11, s10, 9
    s_sub_u32 s12, s10, 10
    s_cmp_lt_u32 s10, 16
    s_cselect_b32 s11, s11, s12
    s_mov_b32 s91, 1
    s_cmp_lt_u32 s10, 9
    s_cselect_b32 s91, 2, s91
    s_cmp_eq_u32 s10, 16
    s_cselect_b32 s91, 2, s91
    s_mul_i32 s11, s11, 4
    s_add_u32 s11, s11, s3
    s_add_u32 s11, s11, 380
    s_mul_i32 s12, s5, 4
    s_add_u32 s12, s12, s3
    s_cmp_lt_u32 s3, 4
    s_cselect_b32 s91, 0, s91
    s_cselect_b32 s11, s12, s11
    s_movk_i32 s12, 88
    s_cselect_b32 s12, 128, s12
    s_lshl_b32 s85, s11, 13
    s_add_u32 s85, s85, s67
    s_and_b32 s85, s85, 0xffffff
    s_add_u32 s11, s11, s12
    s_lshl_b32 s86, s11, 13
    s_add_u32 s86, s86, s67
    s_and_b32 s86, s86, 0xffffff
    s_add_u32 s11, s11, s12
    s_lshl_b32 s87, s11, 13
    s_add_u32 s87, s87, s67
    s_and_b32 s87, s87, 0xffffff
    s_add_u32 s11, s11, s12
    s_cmp_lg_u32 s91, 0
    s_cselect_b32 s87, 16777216, s87
    s_cmp_eq_u32 s91, 2
    s_cselect_b32 s85, 16777216, s85
    s_cselect_b32 s86, 16777216, s86
    s_and_b32 s9, s5, 7
    s_lshl_b32 s9, s9, 2
    s_lshr_b32 s10, s5, 3
    s_add_u32 s9, s9, s10
    s_lshl_b32 s10, s4, 5
    s_add_u32 s9, s9, s10
    v_lshrrev_b32 v6, 1, v1
    v_bfe_u32 v7, v1, 4, 1
    v_lshlrev_b32 v7, 2, v7
    v_xor_b32 v6, v6, v7
    v_lshlrev_b32 v6, 13, v6
    v_and_b32 v7, 1, v1
    v_lshlrev_b32 v7, 4, v7
    v_add_u32 v6, v6, v7
    s_lshl_b32 s11, s9, 5
    s_lshl_b32 s12, s3, 19
    s_add_u32 s11, s11, s12
    s_lshl_b32 s12, s3, 11
    s_add_u32 s12, s12, 131072
    s_lshl_b32 s14, s3, 7
    s_add_u32 s62, s3, s5
    s_and_b32 s62, s62, 1
    s_lshl_b32 s13, s4, 1
    s_add_u32 s62, s62, s13
    s_lshl_b32 s62, s62, 8
    s_add_u32 s62, s62, 4096
    s_waitcnt lgkmcnt(0)
    s_mov_b32 s52, s38
    s_and_b32 s53, s39, 0xffff
    s_mov_b32 s54, 2097152
    s_mov_b32 s55, 0x20000
    s_mov_b32 s68, s16
    s_and_b32 s69, s17, 0xffff
    s_mov_b32 s70, 1024
    s_mov_b32 s71, 0x20000
    s_mov_b32 s72, s22
    s_and_b32 s73, s23, 0xffff
    s_mov_b32 s74, 4194304
    s_mov_b32 s75, 0x20000
    s_cmp_lg_u32 s6, 0
    s_cbranch_scc1 L_nocnt
    v_mov_b32 v4, 0
    s_mov_b64 exec, 1
    buffer_store_dword v4, v4, s[52:55], s62 offen sc1
    buffer_store_dword v4, v4, s[52:55], s62 offen offset:256 sc1
    s_mov_b64 exec, -1
L_nocnt:
    buffer_load_dwordx4 v[32:35], v2, s[68:71], 0 offen
    buffer_load_dwordx4 v[36:39], v3, s[68:71], s14 offen
    buffer_load_dwordx4 v[40:43], v3, s[68:71], s14 offen offset:64
    s_add_u32 s13, s11, 0
    s_add_u32 m0, s12, 0
    s_nop 0
    buffer_load_dwordx4 v6, s[72:75], s13 offen lds
    s_add_u32 s13, s11, 262144
    s_add_u32 m0, s12, 1024
    s_nop 0
    buffer_load_dwordx4 v6, s[72:75], s13 offen lds
    s_add_u32 s40, s18, s7
    s_addc_u32 s41, s19, 0
    s_and_b32 s41, s41, 0xffff
    s_mov_b32 s42, 16777216
    s_mov_b32 s43, 0x20000
    s_add_u32 s44, s20, s7
    s_addc_u32 s45, s21, 0
    s_and_b32 s45, s45, 0xffff
    s_mov_b32 s46, 16777216
    s_mov_b32 s47, 0x20000
    s_mov_b32 s48, s36
    s_and_b32 s49, s37, 0xffff
    s_mov_b32 s50, 256
    s_mov_b32 s51, 0x20000
    s_load_dword s15, s[38:39], 0
    s_mov_b32 s10, s85
    buffer_load_dwordx4 v[124:127], v2, s[44:47], s10 offen offset:0 nt
    buffer_load_dwordx4 v[128:131], v2, s[44:47], s10 offen offset:1024 nt
    buffer_load_dwordx4 v[132:135], v2, s[44:47], s10 offen offset:2048 nt
    buffer_load_dwordx4 v[136:139], v2, s[44:47], s10 offen offset:3072 nt
    s_add_u32 s10, s10, 4096
    buffer_load_dwordx4 v[140:143], v2, s[44:47], s10 offen offset:0 nt
    buffer_load_dwordx4 v[144:147], v2, s[44:47], s10 offen offset:1024 nt
    buffer_load_dwordx4 v[148:151], v2, s[44:47], s10 offen offset:2048 nt
    buffer_load_dwordx4 v[152:155], v2, s[44:47], s10 offen offset:3072 nt
    v_lshrrev_b32 v4, 4, v1
    v_and_b32 v5, 15, v1
    v_lshlrev_b32 v6, 2, v4
    v_xor_b32 v6, v6, v5
    v_lshlrev_b32 v7, 8, v4
    v_xor_b32 v8, 0, v6
    v_lshl_add_u32 v8, v8, 4, v7
    v_xor_b32 v9, 1, v6
    v_lshl_add_u32 v9, v9, 4, v7
    v_xor_b32 v10, 2, v6
    v_lshl_add_u32 v10, v10, 4, v7
    v_xor_b32 v11, 3, v6
    v_lshl_add_u32 v11, v11, 4, v7
    v_and_b32 v6, 3, v1
    v_lshlrev_b32 v6, 10, v6
    v_bfe_u32 v7, v1, 2, 2
    v_lshl_add_u32 v6, v7, 8, v6
    v_xor_b32 v7, v4, v5
    v_lshl_add_u32 v6, v7, 4, v6
    v_add_u32 v6, s60, v6
    v_xor_b32 v12, 0, v6
    v_xor_b32 v13, 64, v6
    v_xor_b32 v14, 128, v6
    v_xor_b32 v15, 192, v6
    s_sub_u32 s10, s5, s4
    s_and_b32 s10, s10, 31
    s_mov_b32 s59, 0
    s_lshl_b32 s11, s4, 2
    s_add_u32 s11, s11, s10
    s_cmp_lt_u32 s10, 4
    s_cselect_b32 s59, 1, s59
    s_cselect_b32 s64, s11, 0
    s_sub_u32 s13, s10, 4
    s_sub_u32 s11, s11, 4
    s_cmp_lt_u32 s13, 4
    s_cselect_b32 s13, s11, 0xffff
    s_cmp_lt_u32 s13, 28
    s_cselect_b32 s59, 2, s59
    s_cselect_b32 s64, s13, s64
    s_lshl_b32 s11, s4, 1
    s_cmp_eq_u32 s10, 8
    s_cselect_b32 s59, 3, s59
    s_cselect_b32 s64, s11, s64
    s_add_u32 s11, s11, 1
    s_cmp_eq_u32 s10, 16
    s_cselect_b32 s59, 3, s59
    s_cselect_b32 s64, s11, s64
    v_bfe_u32 v7, v1, 2, 2
    v_lshlrev_b32 v64, 3, v4
    v_add_u32 v64, v64, v7
    v_and_b32 v65, 1, v4
    v_lshlrev_b32 v65, 2, v65
    v_xor_b32 v64, v64, v65
    v_xor_b32 v65, 4, v64
    v_and_b32 v7, 3, v1
    v_lshlrev_b32 v7, 3, v7
    v_lshlrev_b32 v64, 5, v64
    v_lshlrev_b32 v65, 5, v65
    v_add3_u32 v64, v64, v7, s12
    v_add3_u32 v65, v65, v7, s12
    s_lshl_b32 s11, s3, 6
    s_add_u32 s11, s11, 148736
    v_add_u32 v6, s11, v3
    s_waitcnt vmcnt(12)
    v_lshlrev_b32 v44, 16, v32
    v_and_b32 v45, 0xffff0000, v32
    v_lshlrev_b32 v46, 16, v33
    v_and_b32 v47, 0xffff0000, v33
    v_lshlrev_b32 v48, 16, v34
    v_and_b32 v49, 0xffff0000, v34
    v_lshlrev_b32 v50, 16, v35
    v_and_b32 v51, 0xffff0000, v35
    v_add_f32 v110, v44, v45
    v_add_f32 v110, v110, v46
    v_add_f32 v110, v110, v47
    v_add_f32 v110, v110, v48
    v_add_f32 v110, v110, v49
    v_add_f32 v110, v110, v50
    v_add_f32 v110, v110, v51
    s_nop 1
    v_add_f32_dpp v110, v110, v110 row_ror:8 row_mask:0xf bank_mask:0xf
    s_nop 1
    v_add_f32_dpp v110, v110, v110 row_ror:4 row_mask:0xf bank_mask:0xf
    s_nop 1
    v_add_f32_dpp v110, v110, v110 row_ror:2 row_mask:0xf bank_mask:0xf
    s_nop 1
    v_add_f32_dpp v110, v110, v110 row_ror:1 row_mask:0xf bank_mask:0xf
    v_mov_b32 v111, v110
    s_nop 1
    v_permlane16_swap_b32 v111, v110
    v_add_f32 v110, v111, v110
    v_mov_b32 v111, v110
    s_nop 1
    v_permlane32_swap_b32 v111, v110
    v_add_f32 v110, v111, v110
    v_mul_f32 v110, 0x3b000000, v110
    v_sub_f32 v111, v44, v110
    v_mul_f32 v112, v111, v111
    v_sub_f32 v111, v45, v110
    v_fmac_f32 v112, v111, v111
    v_sub_f32 v111, v46, v110
    v_fmac_f32 v112, v111, v111
    v_sub_f32 v111, v47, v110
    v_fmac_f32 v112, v111, v111
    v_sub_f32 v111, v48, v110
    v_fmac_f32 v112, v111, v111
    v_sub_f32 v111, v49, v110
    v_fmac_f32 v112, v111, v111
    v_sub_f32 v111, v50, v110
    v_fmac_f32 v112, v111, v111
    v_sub_f32 v111, v51, v110
    v_fmac_f32 v112, v111, v111
    s_nop 1
    v_add_f32_dpp v112, v112, v112 row_ror:8 row_mask:0xf bank_mask:0xf
    s_nop 1
    v_add_f32_dpp v112, v112, v112 row_ror:4 row_mask:0xf bank_mask:0xf
    s_nop 1
    v_add_f32_dpp v112, v112, v112 row_ror:2 row_mask:0xf bank_mask:0xf
    s_nop 1
    v_add_f32_dpp v112, v112, v112 row_ror:1 row_mask:0xf bank_mask:0xf
    v_mov_b32 v111, v112
    s_nop 1
    v_permlane16_swap_b32 v111, v112
    v_add_f32 v112, v111, v112
    v_mov_b32 v111, v112
    s_nop 1
    v_permlane32_swap_b32 v111, v112
    v_add_f32 v112, v111, v112
    v_mul_f32 v112, 0x3b000000, v112
    v_cvt_pk_bf16_f32 v113, v110, v110
    v_lshlrev_b32 v113, 16, v113
    v_cvt_pk_bf16_f32 v112, v112, v112
    v_lshlrev_b32 v112, 16, v112
    v_add_f32 v112, 0x3727c5ac, v112
    v_cvt_pk_bf16_f32 v112, v112, v112
    v_lshlrev_b32 v112, 16, v112
    v_sqrt_f32 v112, v112
    s_nop 0
    v_cvt_pk_bf16_f32 v112, v112, v112
    v_lshlrev_b32 v112, 16, v112
    v_rcp_f32 v114, v112
    s_waitcnt vmcnt(10)
    v_lshlrev_b32 v80, 16, v36
    v_and_b32 v81, 0xffff0000, v36
    v_lshlrev_b32 v82, 16, v37
    v_and_b32 v83, 0xffff0000, v37
    v_lshlrev_b32 v84, 16, v38
    v_and_b32 v85, 0xffff0000, v38
    v_lshlrev_b32 v86, 16, v39
    v_and_b32 v87, 0xffff0000, v39
    v_lshlrev_b32 v88, 16, v40
    v_and_b32 v89, 0xffff0000, v40
    v_lshlrev_b32 v90, 16, v41
    v_and_b32 v91, 0xffff0000, v41
    v_lshlrev_b32 v92, 16, v42
    v_and_b32 v93, 0xffff0000, v42
    v_lshlrev_b32 v94, 16, v43
    v_and_b32 v95, 0xffff0000, v43
    v_sub_f32 v80, v80, v113
    v_cvt_pk_bf16_f32 v80, v80, v80
    v_lshlrev_b32 v80, 16, v80
    v_mul_f32 v110, v80, v114
    v_fma_f32 v111, -v110, v112, v80
    v_fma_f32 v80, v111, v114, v110
    v_sub_f32 v81, v81, v113
    v_cvt_pk_bf16_f32 v81, v81, v81
    v_lshlrev_b32 v81, 16, v81
    v_mul_f32 v110, v81, v114
    v_fma_f32 v111, -v110, v112, v81
    v_fma_f32 v81, v111, v114, v110
    v_sub_f32 v82, v82, v113
    v_cvt_pk_bf16_f32 v82, v82, v82
    v_lshlrev_b32 v82, 16, v82
    v_mul_f32 v110, v82, v114
    v_fma_f32 v111, -v110, v112, v82
    v_fma_f32 v82, v111, v114, v110
    v_sub_f32 v83, v83, v113
    v_cvt_pk_bf16_f32 v83, v83, v83
    v_lshlrev_b32 v83, 16, v83
    v_mul_f32 v110, v83, v114
    v_fma_f32 v111, -v110, v112, v83
    v_fma_f32 v83, v111, v114, v110
    v_sub_f32 v84, v84, v113
    v_cvt_pk_bf16_f32 v84, v84, v84
    v_lshlrev_b32 v84, 16, v84
    v_mul_f32 v110, v84, v114
    v_fma_f32 v111, -v110, v112, v84
    v_fma_f32 v84, v111, v114, v110
    v_sub_f32 v85, v85, v113
    v_cvt_pk_bf16_f32 v85, v85, v85
    v_lshlrev_b32 v85, 16, v85
    v_mul_f32 v110, v85, v114
    v_fma_f32 v111, -v110, v112, v85
    v_fma_f32 v85, v111, v114, v110
    v_sub_f32 v86, v86, v113
    v_cvt_pk_bf16_f32 v86, v86, v86
    v_lshlrev_b32 v86, 16, v86
    v_mul_f32 v110, v86, v114
    v_fma_f32 v111, -v110, v112, v86
    v_fma_f32 v86, v111, v114, v110
    v_sub_f32 v87, v87, v113
    v_cvt_pk_bf16_f32 v87, v87, v87
    v_lshlrev_b32 v87, 16, v87
    v_mul_f32 v110, v87, v114
    v_fma_f32 v111, -v110, v112, v87
    v_fma_f32 v87, v111, v114, v110
    v_sub_f32 v88, v88, v113
    v_cvt_pk_bf16_f32 v88, v88, v88
    v_lshlrev_b32 v88, 16, v88
    v_mul_f32 v110, v88, v114
    v_fma_f32 v111, -v110, v112, v88
    v_fma_f32 v88, v111, v114, v110
    v_sub_f32 v89, v89, v113
    v_cvt_pk_bf16_f32 v89, v89, v89
    v_lshlrev_b32 v89, 16, v89
    v_mul_f32 v110, v89, v114
    v_fma_f32 v111, -v110, v112, v89
    v_fma_f32 v89, v111, v114, v110
    v_sub_f32 v90, v90, v113
    v_cvt_pk_bf16_f32 v90, v90, v90
    v_lshlrev_b32 v90, 16, v90
    v_mul_f32 v110, v90, v114
    v_fma_f32 v111, -v110, v112, v90
    v_fma_f32 v90, v111, v114, v110
    v_sub_f32 v91, v91, v113
    v_cvt_pk_bf16_f32 v91, v91, v91
    v_lshlrev_b32 v91, 16, v91
    v_mul_f32 v110, v91, v114
    v_fma_f32 v111, -v110, v112, v91
    v_fma_f32 v91, v111, v114, v110
    v_sub_f32 v92, v92, v113
    v_cvt_pk_bf16_f32 v92, v92, v92
    v_lshlrev_b32 v92, 16, v92
    v_mul_f32 v110, v92, v114
    v_fma_f32 v111, -v110, v112, v92
    v_fma_f32 v92, v111, v114, v110
    v_sub_f32 v93, v93, v113
    v_cvt_pk_bf16_f32 v93, v93, v93
    v_lshlrev_b32 v93, 16, v93
    v_mul_f32 v110, v93, v114
    v_fma_f32 v111, -v110, v112, v93
    v_fma_f32 v93, v111, v114, v110
    v_sub_f32 v94, v94, v113
    v_cvt_pk_bf16_f32 v94, v94, v94
    v_lshlrev_b32 v94, 16, v94
    v_mul_f32 v110, v94, v114
    v_fma_f32 v111, -v110, v112, v94
    v_fma_f32 v94, v111, v114, v110
    v_sub_f32 v95, v95, v113
    v_cvt_pk_bf16_f32 v95, v95, v95
    v_lshlrev_b32 v95, 16, v95
    v_mul_f32 v110, v95, v114
    v_fma_f32 v111, -v110, v112, v95
    v_fma_f32 v95, v111, v114, v110
    v_cvt_pk_bf16_f32 v36, v80, v81
    v_cvt_pk_bf16_f32 v37, v82, v83
    v_cvt_pk_bf16_f32 v38, v84, v85
    v_cvt_pk_bf16_f32 v39, v86, v87
    v_cvt_pk_bf16_f32 v40, v88, v89
    v_cvt_pk_bf16_f32 v41, v90, v91
    v_cvt_pk_bf16_f32 v42, v92, v93
    v_cvt_pk_bf16_f32 v43, v94, v95
    s_waitcnt vmcnt(8)
    ds_read_b64_tr_b16 v[16:17], v64 offset:0
    ds_read_b64_tr_b16 v[18:19], v65 offset:0
    ds_read_b64_tr_b16 v[20:21], v64 offset:1024
    ds_read_b64_tr_b16 v[22:23], v65 offset:1024
    s_waitcnt lgkmcnt(0)
    v_mfma_f32_16x16x32_bf16 v[96:99], v[16:19], v[36:39], 0
    v_mfma_f32_16x16x32_bf16 v[96:99], v[20:23], v[40:43], v[96:99]
    s_nop 7
    ds_write_b128 v6, v[96:99]
    v_mov_b32 v6, 149248
    v_mov_b32 v7, 0
    ds_write_b32 v6, v7
    s_waitcnt lgkmcnt(0)
    s_barrier
    s_cmp_lg_u32 s3, 0
    s_cbranch_scc1 L_pubq_done
    v_lshlrev_b32 v6, 2, v5
    v_add_u32 v7, 148736, v6
    ds_read_b32 v80, v7 offset:0
    ds_read_b32 v81, v7 offset:64
    ds_read_b32 v82, v7 offset:128
    ds_read_b32 v83, v7 offset:192
    ds_read_b32 v84, v7 offset:256
    ds_read_b32 v85, v7 offset:320
    ds_read_b32 v86, v7 offset:384
    ds_read_b32 v87, v7 offset:448
    s_add_u32 s15, s15, 1
    s_lshl_b32 s11, s9, 6
    s_add_u32 s11, s11, 16384
    v_mov_b32 v89, s15
    s_waitcnt lgkmcnt(0)
    v_add_f32 v80, v80, v81
    v_add_f32 v80, v80, v82
    v_add_f32 v80, v80, v83
    v_add_f32 v80, v80, v84
    v_add_f32 v80, v80, v85
    v_add_f32 v80, v80, v86
    v_add_f32 v80, v80, v87
    s_nop 1
    v_mov_b32_dpp v81, v80 quad_perm:[1,0,3,2] row_mask:0xf bank_mask:0xf
    v_cvt_pk_bf16_f32 v88, v80, v81
    s_mov_b64 exec, 0x5555
    buffer_store_dwordx2 v[88:89], v6, s[52:55], s11 offen sc1
    s_mov_b64 exec, -1
L_pubq_done:
    s_barrier
    s_mov_b32 s9, s64
    s_cmp_eq_u32 s59, 0
    s_cbranch_scc1 L_fillN
    s_cmp_eq_u32 s59, 3
    s_cbranch_scc1 L_fillD
    v_bfe_u32 v4, v1, 1, 2
    v_bfe_u32 v5, v1, 4, 1
    v_xor_b32 v4, v4, v5
    v_lshlrev_b32 v4, 5, v4
    v_and_b32 v5, 1, v1
    v_lshl_add_u32 v4, v5, 4, v4
    v_xor_b32 v5, 64, v4
    v_lshrrev_b32 v6, 3, v1
    s_cmp_eq_u32 s59, 2
    s_nop 0
    s_cbranch_scc1 L_fillC
    s_lshl_b32 s11, s9, 17
    s_add_u32 s68, s24, s11
    s_addc_u32 s69, s25, 0
    s_and_b32 s69, s69, 0xffff
    s_mov_b32 s70, 131072
    s_mov_b32 s71, 0x20000
    v_lshl_add_u32 v4, v6, 10, v4
    v_lshl_add_u32 v5, v6, 10, v5
    s_lshl_b32 s11, s3, 7
    s_cmp_eq_u32 s3, 0
    s_cbranch_scc1 L_f0_B
    s_waitcnt vmcnt(3)
    s_add_u32 s13, s11, 0
    s_add_u32 m0, s60, 0
    s_nop 0
    buffer_load_dwordx4 v4, s[68:71], s13 offen nt lds
    s_waitcnt vmcnt(3)
    s_add_u32 s13, s11, 8192
    s_add_u32 m0, s60, 1024
    s_nop 0
    buffer_load_dwordx4 v5, s[68:71], s13 offen nt lds
    s_waitcnt vmcnt(3)
    s_add_u32 s13, s11, 16384
    s_add_u32 m0, s60, 2048
    s_nop 0
    buffer_load_dwordx4 v4, s[68:71], s13 offen nt lds
    s_waitcnt vmcnt(3)
    s_add_u32 s13, s11, 24576
    s_add_u32 m0, s60, 3072
    s_nop 0
    buffer_load_dwordx4 v5, s[68:71], s13 offen nt lds
    s_waitcnt vmcnt(3)
    s_add_u32 s13, s11, 32768
    s_add_u32 m0, s60, 4096
    s_nop 0
    buffer_load_dwordx4 v4, s[68:71], s13 offen nt lds
    s_waitcnt vmcnt(3)
    s_add_u32 s13, s11, 40960
    s_add_u32 m0, s60, 5120
    s_nop 0
    buffer_load_dwordx4 v5, s[68:71], s13 offen nt lds
    s_waitcnt vmcnt(3)
    s_add_u32 s13, s11, 49152
    s_add_u32 m0, s60, 6144
    s_nop 0
    buffer_load_dwordx4 v4, s[68:71], s13 offen nt lds
    s_waitcnt vmcnt(3)
    s_add_u32 s13, s11, 57344
    s_add_u32 m0, s60, 7168
    s_nop 0
    buffer_load_dwordx4 v5, s[68:71], s13 offen nt lds
    s_waitcnt vmcnt(3)
    s_add_u32 s13, s11, 65536
    s_add_u32 m0, s60, 8192
    s_nop 0
    buffer_load_dwordx4 v4, s[68:71], s13 offen nt lds
    s_waitcnt vmcnt(3)
    s_add_u32 s13, s11, 73728
    s_add_u32 m0, s60, 9216
    s_nop 0
    buffer_load_dwordx4 v5, s[68:71], s13 offen nt lds
    s_waitcnt vmcnt(3)
    s_add_u32 s13, s11, 81920
    s_add_u32 m0, s60, 10240
    s_nop 0
    buffer_load_dwordx4 v4, s[68:71], s13 offen nt lds
    s_waitcnt vmcnt(3)
    s_add_u32 s13, s11, 90112
    s_add_u32 m0, s60, 11264
    s_nop 0
    buffer_load_dwordx4 v5, s[68:71], s13 offen nt lds
    s_waitcnt vmcnt(3)
    s_add_u32 s13, s11, 98304
    s_add_u32 m0, s60, 12288
    s_nop 0
    buffer_load_dwordx4 v4, s[68:71], s13 offen nt lds
    s_waitcnt vmcnt(3)
    s_add_u32 s13, s11, 106496
    s_add_u32 m0, s60, 13312
    s_nop 0
    buffer_load_dwordx4 v5, s[68:71], s13 offen nt lds
    s_waitcnt vmcnt(3)
    s_add_u32 s13, s11, 114688
    s_add_u32 m0, s60, 14336
    s_nop 0
    buffer_load_dwordx4 v4, s[68:71], s13 offen nt lds
    s_waitcnt vmcnt(3)
    s_add_u32 s13, s11, 122880
    s_add_u32 m0, s60, 15360
    s_nop 0
    buffer_load_dwordx4 v5, s[68:71], s13 offen nt lds
    s_branch L_fill_done
L_f0_B:
    s_add_u32 s13, s11, 0
    s_add_u32 m0, s60, 0
    s_nop 0
    buffer_load_dwordx4 v4, s[68:71], s13 offen nt lds
    s_add_u32 s13, s11, 8192
    s_add_u32 m0, s60, 1024
    s_nop 0
    buffer_load_dwordx4 v5, s[68:71], s13 offen nt lds
    s_add_u32 s13, s11, 16384
    s_add_u32 m0, s60, 2048
    s_nop 0
    buffer_load_dwordx4 v4, s[68:71], s13 offen nt lds
    s_add_u32 s13, s11, 24576
    s_add_u32 m0, s60, 3072
    s_nop 0
    buffer_load_dwordx4 v5, s[68:71], s13 offen nt lds
    s_add_u32 s13, s11, 32768
    s_add_u32 m0, s60, 4096
    s_nop 0
    buffer_load_dwordx4 v4, s[68:71], s13 offen nt lds
    s_add_u32 s13, s11, 40960
    s_add_u32 m0, s60, 5120
    s_nop 0
    buffer_load_dwordx4 v5, s[68:71], s13 offen nt lds
    s_add_u32 s13, s11, 49152
    s_add_u32 m0, s60, 6144
    s_nop 0
    buffer_load_dwordx4 v4, s[68:71], s13 offen nt lds
    s_add_u32 s13, s11, 57344
    s_add_u32 m0, s60, 7168
    s_nop 0
    buffer_load_dwordx4 v5, s[68:71], s13 offen nt lds
    s_add_u32 s13, s11, 65536
    s_add_u32 m0, s60, 8192
    s_nop 0
    buffer_load_dwordx4 v4, s[68:71], s13 offen nt lds
    s_add_u32 s13, s11, 73728
    s_add_u32 m0, s60, 9216
    s_nop 0
    buffer_load_dwordx4 v5, s[68:71], s13 offen nt lds
    s_add_u32 s13, s11, 81920
    s_add_u32 m0, s60, 10240
    s_nop 0
    buffer_load_dwordx4 v4, s[68:71], s13 offen nt lds
    s_add_u32 s13, s11, 90112
    s_add_u32 m0, s60, 11264
    s_nop 0
    buffer_load_dwordx4 v5, s[68:71], s13 offen nt lds
    s_add_u32 s13, s11, 98304
    s_add_u32 m0, s60, 12288
    s_nop 0
    buffer_load_dwordx4 v4, s[68:71], s13 offen nt lds
    s_add_u32 s13, s11, 106496
    s_add_u32 m0, s60, 13312
    s_nop 0
    buffer_load_dwordx4 v5, s[68:71], s13 offen nt lds
    s_add_u32 s13, s11, 114688
    s_add_u32 m0, s60, 14336
    s_nop 0
    buffer_load_dwordx4 v4, s[68:71], s13 offen nt lds
    s_add_u32 s13, s11, 122880
    s_add_u32 m0, s60, 15360
    s_nop 0
    buffer_load_dwordx4 v5, s[68:71], s13 offen nt lds
    s_branch L_fill_done
L_fillC:
    s_mov_b32 s68, s28
    s_and_b32 s69, s29, 0xffff
    s_mov_b32 s70, 1835008
    s_mov_b32 s71, 0x20000
    s_mov_b32 s72, s30
    s_and_b32 s73, s31, 0xffff
    s_mov_b32 s74, 1835008
    s_mov_b32 s75, 0x20000
    s_movk_i32 s11, 3584
    v_mul_lo_u32 v6, v6, s11
    v_add_u32 v4, v4, v6
    v_add_u32 v5, v5, v6
    s_lshl_b32 s11, s9, 7
    s_mul_i32 s13, s3, 229376
    s_add_u32 s11, s11, s13
    s_cmp_eq_u32 s3, 0
    s_cbranch_scc1 L_f0_C
    s_waitcnt vmcnt(3)
    s_add_u32 s13, s11, 0
    s_add_u32 m0, s60, 0
    s_nop 0
    buffer_load_dwordx4 v4, s[68:71], s13 offen nt lds
    s_waitcnt vmcnt(3)
    s_add_u32 s13, s11, 28672
    s_add_u32 m0, s60, 1024
    s_nop 0
    buffer_load_dwordx4 v5, s[68:71], s13 offen nt lds
    s_waitcnt vmcnt(3)
    s_add_u32 s13, s11, 57344
    s_add_u32 m0, s60, 2048
    s_nop 0
    buffer_load_dwordx4 v4, s[68:71], s13 offen nt lds
    s_waitcnt vmcnt(3)
    s_add_u32 s13, s11, 86016
    s_add_u32 m0, s60, 3072
    s_nop 0
    buffer_load_dwordx4 v5, s[68:71], s13 offen nt lds
    s_waitcnt vmcnt(3)
    s_add_u32 s13, s11, 114688
    s_add_u32 m0, s60, 4096
    s_nop 0
    buffer_load_dwordx4 v4, s[68:71], s13 offen nt lds
    s_waitcnt vmcnt(3)
    s_add_u32 s13, s11, 143360
    s_add_u32 m0, s60, 5120
    s_nop 0
    buffer_load_dwordx4 v5, s[68:71], s13 offen nt lds
    s_waitcnt vmcnt(3)
    s_add_u32 s13, s11, 172032
    s_add_u32 m0, s60, 6144
    s_nop 0
    buffer_load_dwordx4 v4, s[68:71], s13 offen nt lds
    s_waitcnt vmcnt(3)
    s_add_u32 s13, s11, 200704
    s_add_u32 m0, s60, 7168
    s_nop 0
    buffer_load_dwordx4 v5, s[68:71], s13 offen nt lds
    s_waitcnt vmcnt(3)
    s_add_u32 s13, s11, 0
    s_add_u32 m0, s60, 8192
    s_nop 0
    buffer_load_dwordx4 v4, s[72:75], s13 offen nt lds
    s_waitcnt vmcnt(3)
    s_add_u32 s13, s11, 28672
    s_add_u32 m0, s60, 9216
    s_nop 0
    buffer_load_dwordx4 v5, s[72:75], s13 offen nt lds
    s_waitcnt vmcnt(3)
    s_add_u32 s13, s11, 57344
    s_add_u32 m0, s60, 10240
    s_nop 0
    buffer_load_dwordx4 v4, s[72:75], s13 offen nt lds
    s_waitcnt vmcnt(3)
    s_add_u32 s13, s11, 86016
    s_add_u32 m0, s60, 11264
    s_nop 0
    buffer_load_dwordx4 v5, s[72:75], s13 offen nt lds
    s_waitcnt vmcnt(3)
    s_add_u32 s13, s11, 114688
    s_add_u32 m0, s60, 12288
    s_nop 0
    buffer_load_dwordx4 v4, s[72:75], s13 offen nt lds
    s_waitcnt vmcnt(3)
    s_add_u32 s13, s11, 143360
    s_add_u32 m0, s60, 13312
    s_nop 0
    buffer_load_dwordx4 v5, s[72:75], s13 offen nt lds
    s_waitcnt vmcnt(3)
    s_add_u32 s13, s11, 172032
    s_add_u32 m0, s60, 14336
    s_nop 0
    buffer_load_dwordx4 v4, s[72:75], s13 offen nt lds
    s_waitcnt vmcnt(3)
    s_add_u32 s13, s11, 200704
    s_add_u32 m0, s60, 15360
    s_nop 0
    buffer_load_dwordx4 v5, s[72:75], s13 offen nt lds
    s_branch L_fill_done
L_f0_C:
    s_add_u32 s13, s11, 0
    s_add_u32 m0, s60, 0
    s_nop 0
    buffer_load_dwordx4 v4, s[68:71], s13 offen nt lds
    s_add_u32 s13, s11, 28672
    s_add_u32 m0, s60, 1024
    s_nop 0
    buffer_load_dwordx4 v5, s[68:71], s13 offen nt lds
    s_add_u32 s13, s11, 57344
    s_add_u32 m0, s60, 2048
    s_nop 0
    buffer_load_dwordx4 v4, s[68:71], s13 offen nt lds
    s_add_u32 s13, s11, 86016
    s_add_u32 m0, s60, 3072
    s_nop 0
    buffer_load_dwordx4 v5, s[68:71], s13 offen nt lds
    s_add_u32 s13, s11, 114688
    s_add_u32 m0, s60, 4096
    s_nop 0
    buffer_load_dwordx4 v4, s[68:71], s13 offen nt lds
    s_add_u32 s13, s11, 143360
    s_add_u32 m0, s60, 5120
    s_nop 0
    buffer_load_dwordx4 v5, s[68:71], s13 offen nt lds
    s_add_u32 s13, s11, 172032
    s_add_u32 m0, s60, 6144
    s_nop 0
    buffer_load_dwordx4 v4, s[68:71], s13 offen nt lds
    s_add_u32 s13, s11, 200704
    s_add_u32 m0, s60, 7168
    s_nop 0
    buffer_load_dwordx4 v5, s[68:71], s13 offen nt lds
    s_add_u32 s13, s11, 0
    s_add_u32 m0, s60, 8192
    s_nop 0
    buffer_load_dwordx4 v4, s[72:75], s13 offen nt lds
    s_add_u32 s13, s11, 28672
    s_add_u32 m0, s60, 9216
    s_nop 0
    buffer_load_dwordx4 v5, s[72:75], s13 offen nt lds
    s_add_u32 s13, s11, 57344
    s_add_u32 m0, s60, 10240
    s_nop 0
    buffer_load_dwordx4 v4, s[72:75], s13 offen nt lds
    s_add_u32 s13, s11, 86016
    s_add_u32 m0, s60, 11264
    s_nop 0
    buffer_load_dwordx4 v5, s[72:75], s13 offen nt lds
    s_add_u32 s13, s11, 114688
    s_add_u32 m0, s60, 12288
    s_nop 0
    buffer_load_dwordx4 v4, s[72:75], s13 offen nt lds
    s_add_u32 s13, s11, 143360
    s_add_u32 m0, s60, 13312
    s_nop 0
    buffer_load_dwordx4 v5, s[72:75], s13 offen nt lds
    s_add_u32 s13, s11, 172032
    s_add_u32 m0, s60, 14336
    s_nop 0
    buffer_load_dwordx4 v4, s[72:75], s13 offen nt lds
    s_add_u32 s13, s11, 200704
    s_add_u32 m0, s60, 15360
    s_nop 0
    buffer_load_dwordx4 v5, s[72:75], s13 offen nt lds
    s_branch L_fill_done
L_fillD:
    s_mov_b32 s68, s32
    s_and_b32 s69, s33, 0xffff
    s_mov_b32 s70, 1835008
    s_mov_b32 s71, 0x20000
    v_and_b32 v4, 3, v1
    v_bfe_u32 v5, v1, 5, 1
    v_lshlrev_b32 v5, 1, v5
    v_xor_b32 v4, v4, v5
    v_lshlrev_b32 v4, 4, v4
    v_lshrrev_b32 v5, 2, v1
    v_lshl_add_u32 v4, v5, 10, v4
    s_lshl_b32 s11, s9, 6
    s_mul_i32 s13, s3, 229376
    s_add_u32 s11, s11, s13
    s_cmp_eq_u32 s3, 0
    s_cbranch_scc1 L_f0_D
    s_waitcnt vmcnt(3)
    s_add_u32 s13, s11, 0
    s_add_u32 m0, s60, 0
    s_nop 0
    buffer_load_dwordx4 v4, s[68:71], s13 offen lds
    s_waitcnt vmcnt(3)
    s_add_u32 s13, s11, 16384
    s_add_u32 m0, s60, 1024
    s_nop 0
    buffer_load_dwordx4 v4, s[68:71], s13 offen lds
    s_waitcnt vmcnt(3)
    s_add_u32 s13, s11, 32768
    s_add_u32 m0, s60, 2048
    s_nop 0
    buffer_load_dwordx4 v4, s[68:71], s13 offen lds
    s_waitcnt vmcnt(3)
    s_add_u32 s13, s11, 49152
    s_add_u32 m0, s60, 3072
    s_nop 0
    buffer_load_dwordx4 v4, s[68:71], s13 offen lds
    s_waitcnt vmcnt(3)
    s_add_u32 s13, s11, 65536
    s_add_u32 m0, s60, 4096
    s_nop 0
    buffer_load_dwordx4 v4, s[68:71], s13 offen lds
    s_waitcnt vmcnt(3)
    s_add_u32 s13, s11, 81920
    s_add_u32 m0, s60, 5120
    s_nop 0
    buffer_load_dwordx4 v4, s[68:71], s13 offen lds
    s_waitcnt vmcnt(3)
    s_add_u32 s13, s11, 98304
    s_add_u32 m0, s60, 6144
    s_nop 0
    buffer_load_dwordx4 v4, s[68:71], s13 offen lds
    s_waitcnt vmcnt(3)
    s_add_u32 s13, s11, 114688
    s_add_u32 m0, s60, 7168
    s_nop 0
    buffer_load_dwordx4 v4, s[68:71], s13 offen lds
    s_waitcnt vmcnt(3)
    s_add_u32 s13, s11, 131072
    s_add_u32 m0, s60, 8192
    s_nop 0
    buffer_load_dwordx4 v4, s[68:71], s13 offen lds
    s_waitcnt vmcnt(3)
    s_add_u32 s13, s11, 147456
    s_add_u32 m0, s60, 9216
    s_nop 0
    buffer_load_dwordx4 v4, s[68:71], s13 offen lds
    s_waitcnt vmcnt(3)
    s_add_u32 s13, s11, 163840
    s_add_u32 m0, s60, 10240
    s_nop 0
    buffer_load_dwordx4 v4, s[68:71], s13 offen lds
    s_waitcnt vmcnt(3)
    s_add_u32 s13, s11, 180224
    s_add_u32 m0, s60, 11264
    s_nop 0
    buffer_load_dwordx4 v4, s[68:71], s13 offen lds
    s_waitcnt vmcnt(3)
    s_add_u32 s13, s11, 196608
    s_add_u32 m0, s60, 12288
    s_nop 0
    buffer_load_dwordx4 v4, s[68:71], s13 offen lds
    s_waitcnt vmcnt(3)
    s_add_u32 s13, s11, 212992
    s_add_u32 m0, s60, 13312
    s_nop 0
    buffer_load_dwordx4 v4, s[68:71], s13 offen lds
    s_branch L_fill_done
L_f0_D:
    s_add_u32 s13, s11, 0
    s_add_u32 m0, s60, 0
    s_nop 0
    buffer_load_dwordx4 v4, s[68:71], s13 offen lds
    s_add_u32 s13, s11, 16384
    s_add_u32 m0, s60, 1024
    s_nop 0
    buffer_load_dwordx4 v4, s[68:71], s13 offen lds
    s_add_u32 s13, s11, 32768
    s_add_u32 m0, s60, 2048
    s_nop 0
    buffer_load_dwordx4 v4, s[68:71], s13 offen lds
    s_add_u32 s13, s11, 49152
    s_add_u32 m0, s60, 3072
    s_nop 0
    buffer_load_dwordx4 v4, s[68:71], s13 offen lds
    s_add_u32 s13, s11, 65536
    s_add_u32 m0, s60, 4096
    s_nop 0
    buffer_load_dwordx4 v4, s[68:71], s13 offen lds
    s_add_u32 s13, s11, 81920
    s_add_u32 m0, s60, 5120
    s_nop 0
    buffer_load_dwordx4 v4, s[68:71], s13 offen lds
    s_add_u32 s13, s11, 98304
    s_add_u32 m0, s60, 6144
    s_nop 0
    buffer_load_dwordx4 v4, s[68:71], s13 offen lds
    s_add_u32 s13, s11, 114688
    s_add_u32 m0, s60, 7168
    s_nop 0
    buffer_load_dwordx4 v4, s[68:71], s13 offen lds
    s_add_u32 s13, s11, 131072
    s_add_u32 m0, s60, 8192
    s_nop 0
    buffer_load_dwordx4 v4, s[68:71], s13 offen lds
    s_add_u32 s13, s11, 147456
    s_add_u32 m0, s60, 9216
    s_nop 0
    buffer_load_dwordx4 v4, s[68:71], s13 offen lds
    s_add_u32 s13, s11, 163840
    s_add_u32 m0, s60, 10240
    s_nop 0
    buffer_load_dwordx4 v4, s[68:71], s13 offen lds
    s_add_u32 s13, s11, 180224
    s_add_u32 m0, s60, 11264
    s_nop 0
    buffer_load_dwordx4 v4, s[68:71], s13 offen lds
    s_add_u32 s13, s11, 196608
    s_add_u32 m0, s60, 12288
    s_nop 0
    buffer_load_dwordx4 v4, s[68:71], s13 offen lds
    s_add_u32 s13, s11, 212992
    s_add_u32 m0, s60, 13312
    s_nop 0
    buffer_load_dwordx4 v4, s[68:71], s13 offen lds
    s_branch L_fill_done
L_fillN:
L_fill_done:
    s_cmp_lg_u32 s3, 0
    s_cbranch_scc1 L_w17_rest
    s_cmp_lg_u32 s59, 0
    s_cbranch_scc1 L_w0_poll
    s_mov_b32 s10, s86
    buffer_load_dwordx4 v[156:159], v2, s[44:47], s10 offen offset:0 nt
    buffer_load_dwordx4 v[160:163], v2, s[44:47], s10 offen offset:1024 nt
    buffer_load_dwordx4 v[164:167], v2, s[44:47], s10 offen offset:2048 nt
    buffer_load_dwordx4 v[168:171], v2, s[44:47], s10 offen offset:3072 nt
    s_add_u32 s10, s10, 4096
    buffer_load_dwordx4 v[172:175], v2, s[44:47], s10 offen offset:0 nt
    buffer_load_dwordx4 v[176:179], v2, s[44:47], s10 offen offset:1024 nt
    buffer_load_dwordx4 v[180:183], v2, s[44:47], s10 offen offset:2048 nt
    buffer_load_dwordx4 v[184:187], v2, s[44:47], s10 offen offset:3072 nt
    s_mov_b32 s10, s85
    s_add_u32 m0, s60, 0
    s_nop 0
    buffer_load_dwordx4 v8, s[40:43], s10 offen offset:0 nt lds
    buffer_load_dwordx4 v9, s[40:43], s10 offen offset:1024 nt lds
    buffer_load_dwordx4 v10, s[40:43], s10 offen offset:2048 nt lds
    buffer_load_dwordx4 v11, s[40:43], s10 offen offset:3072 nt lds
    s_add_u32 s10, s10, 4096
    s_add_u32 m0, s60, 4096
    s_nop 0
    buffer_load_dwordx4 v8, s[40:43], s10 offen offset:0 nt lds
    buffer_load_dwordx4 v9, s[40:43], s10 offen offset:1024 nt lds
    buffer_load_dwordx4 v10, s[40:43], s10 offen offset:2048 nt lds
    buffer_load_dwordx4 v11, s[40:43], s10 offen offset:3072 nt lds
L_w0_poll:
    s_lshl_b32 s11, s4, 11
    s_add_u32 s11, s11, 16384
    s_mov_b32 s57, 20000
L_pq_loop:
    buffer_load_dwordx4 v[80:83], v2, s[52:55], s11 offen sc1
    buffer_load_dwordx4 v[84:87], v2, s[52:55], s11 offen offset:1024 sc1
    s_waitcnt vmcnt(0)
    v_xor_b32 v81, s15, v81
    v_xor_b32 v83, s15, v83
    v_xor_b32 v85, s15, v85
    v_xor_b32 v87, s15, v87
    v_or3_b32 v81, v81, v83, v85
    v_or_b32 v81, v81, v87
    v_cmp_ne_u32 vcc, 0, v81
    s_nop 0
    s_cmp_eq_u64 vcc, 0
    s_nop 2
    s_cbranch_scc1 L_pq_done
    s_sub_u32 s57, s57, 1
    s_cmp_eq_u32 s57, 0
    s_cbranch_scc1 L_pq_done
    s_sleep 1
    s_branch L_pq_loop
L_pq_done:
    v_lshlrev_b32 v6, 3, v1
    v_add_u32 v6, 147712, v6
    v_mov_b32 v81, v82
    v_mov_b32 v85, v86
    ds_write_b64 v6, v[80:81]
    ds_write_b64 v6, v[84:85] offset:512
    v_mov_b32 v6, 149248
    v_mov_b32 v7, 1
    s_waitcnt lgkmcnt(0)
    ds_write_b32 v6, v7
    v_mov_b32 v88, -1
    v_mov_b32 v89, -1
    v_mov_b32 v90, -1
    v_mov_b32 v91, -1
    v_lshrrev_b32 v6, 5, v1
    v_lshlrev_b32 v6, 14, v6
    v_and_b32 v7, 31, v1
    v_lshl_add_u32 v6, v7, 4, v6
    s_lshl_b32 s11, s4, 16
    s_lshl_b32 s13, s5, 9
    s_add_u32 s11, s11, s13
    s_add_u32 s11, s11, 147456
    buffer_store_dwordx4 v[88:91], v6, s[52:55], s11 offen sc1
    s_add_u32 s11, s11, 0x8000
    buffer_store_dwordx4 v[88:91], v6, s[52:55], s11 offen sc1
    v_lshlrev_b32 v6, 8, v1
    s_lshl_b32 s11, s4, 10
    s_lshl_b32 s13, s5, 3
    s_add_u32 s11, s11, s13
    s_add_u32 s11, s11, 671744
    s_mov_b64 exec, 0xf
    buffer_store_dwordx2 v[88:89], v6, s[52:55], s11 offen sc1
    s_mov_b64 exec, -1
    s_cmp_eq_u32 s59, 1
    s_cbranch_scc1 L_rst_B
    s_cmp_lg_u32 s59, 2
    s_cbranch_scc1 L_rst_done
    s_lshl_b32 s11, s9, 7
    s_add_u32 s11, s11, 139264
    s_mov_b64 exec, 0xff
    buffer_store_dwordx4 v[88:91], v2, s[52:55], s11 offen sc1
    s_mov_b64 exec, -1
    s_cmp_lg_u32 s9, 0
    s_cbranch_scc1 L_rst_done
    s_mov_b32 s11, 143360
    s_branch L_rst_2k
L_rst_B:
    s_lshl_b32 s11, s9, 11
    s_add_u32 s11, s11, 73728
L_rst_2k:
    buffer_store_dwordx4 v[88:91], v2, s[52:55], s11 offen sc1
    buffer_store_dwordx4 v[88:91], v2, s[52:55], s11 offen offset:1024 sc1
    s_nop 1
L_rst_done:
    s_cmp_lg_u32 s59, 0
    s_cbranch_scc1 L_w0_role
    s_mov_b32 s10, s86
    s_add_u32 m0, s60, 8192
    s_nop 0
    buffer_load_dwordx4 v8, s[40:43], s10 offen offset:0 nt lds
    buffer_load_dwordx4 v9, s[40:43], s10 offen offset:1024 nt lds
    buffer_load_dwordx4 v10, s[40:43], s10 offen offset:2048 nt lds
    buffer_load_dwordx4 v11, s[40:43], s10 offen offset:3072 nt lds
    s_add_u32 s10, s10, 4096
    s_add_u32 m0, s60, 12288
    s_nop 0
    buffer_load_dwordx4 v8, s[40:43], s10 offen offset:0 nt lds
    buffer_load_dwordx4 v9, s[40:43], s10 offen offset:1024 nt lds
    buffer_load_dwordx4 v10, s[40:43], s10 offen offset:2048 nt lds
    buffer_load_dwordx4 v11, s[40:43], s10 offen offset:3072 nt lds
    s_branch L_haveq
L_w0_role:
    s_mov_b32 s10, s86
    buffer_load_dwordx4 v[156:159], v2, s[44:47], s10 offen offset:0 nt
    buffer_load_dwordx4 v[160:163], v2, s[44:47], s10 offen offset:1024 nt
    buffer_load_dwordx4 v[164:167], v2, s[44:47], s10 offen offset:2048 nt
    buffer_load_dwordx4 v[168:171], v2, s[44:47], s10 offen offset:3072 nt
    s_add_u32 s10, s10, 4096
    buffer_load_dwordx4 v[172:175], v2, s[44:47], s10 offen offset:0 nt
    buffer_load_dwordx4 v[176:179], v2, s[44:47], s10 offen offset:1024 nt
    buffer_load_dwordx4 v[180:183], v2, s[44:47], s10 offen offset:2048 nt
    buffer_load_dwordx4 v[184:187], v2, s[44:47], s10 offen offset:3072 nt
    s_branch L_role_w
L_w17_rest:
    s_cmp_lg_u32 s59, 0
    s_cbranch_scc1 L_w17_role
    s_waitcnt vmcnt(3)
    s_mov_b32 s10, s86
    buffer_load_dwordx4 v[156:159], v2, s[44:47], s10 offen offset:0 nt
    s_waitcnt vmcnt(3)
    buffer_load_dwordx4 v[160:163], v2, s[44:47], s10 offen offset:1024 nt
    s_waitcnt vmcnt(3)
    buffer_load_dwordx4 v[164:167], v2, s[44:47], s10 offen offset:2048 nt
    s_waitcnt vmcnt(3)
    buffer_load_dwordx4 v[168:171], v2, s[44:47], s10 offen offset:3072 nt
    s_waitcnt vmcnt(3)
    s_add_u32 s10, s10, 4096
    buffer_load_dwordx4 v[172:175], v2, s[44:47], s10 offen offset:0 nt
    s_waitcnt vmcnt(3)
    buffer_load_dwordx4 v[176:179], v2, s[44:47], s10 offen offset:1024 nt
    s_waitcnt vmcnt(3)
    buffer_load_dwordx4 v[180:183], v2, s[44:47], s10 offen offset:2048 nt
    s_waitcnt vmcnt(3)
    buffer_load_dwordx4 v[184:187], v2, s[44:47], s10 offen offset:3072 nt
    s_waitcnt vmcnt(3)
    s_mov_b32 s10, s85
    s_add_u32 m0, s60, 0
    s_nop 0
    buffer_load_dwordx4 v8, s[40:43], s10 offen offset:0 nt lds
    s_waitcnt vmcnt(3)
    buffer_load_dwordx4 v9, s[40:43], s10 offen offset:1024 nt lds
    s_waitcnt vmcnt(3)
    buffer_load_dwordx4 v10, s[40:43], s10 offen offset:2048 nt lds
    s_waitcnt vmcnt(3)
    buffer_load_dwordx4 v11, s[40:43], s10 offen offset:3072 nt lds
    s_waitcnt vmcnt(3)
    s_add_u32 s10, s10, 4096
    s_add_u32 m0, s60, 4096
    s_nop 0
    buffer_load_dwordx4 v8, s[40:43], s10 offen offset:0 nt lds
    s_waitcnt vmcnt(3)
    buffer_load_dwordx4 v9, s[40:43], s10 offen offset:1024 nt lds
    s_waitcnt vmcnt(3)
    buffer_load_dwordx4 v10, s[40:43], s10 offen offset:2048 nt lds
    s_waitcnt vmcnt(3)
    buffer_load_dwordx4 v11, s[40:43], s10 offen offset:3072 nt lds
    s_waitcnt vmcnt(3)
    s_mov_b32 s10, s86
    s_add_u32 m0, s60, 8192
    s_nop 0
    buffer_load_dwordx4 v8, s[40:43], s10 offen offset:0 nt lds
    s_waitcnt vmcnt(3)
    buffer_load_dwordx4 v9, s[40:43], s10 offen offset:1024 nt lds
    s_waitcnt vmcnt(3)
    buffer_load_dwordx4 v10, s[40:43], s10 offen offset:2048 nt lds
    s_waitcnt vmcnt(3)
    buffer_load_dwordx4 v11, s[40:43], s10 offen offset:3072 nt lds
    s_waitcnt vmcnt(3)
    s_add_u32 s10, s10, 4096
    s_add_u32 m0, s60, 12288
    s_nop 0
    buffer_load_dwordx4 v8, s[40:43], s10 offen offset:0 nt lds
    s_waitcnt vmcnt(3)
    buffer_load_dwordx4 v9, s[40:43], s10 offen offset:1024 nt lds
    s_waitcnt vmcnt(3)
    buffer_load_dwordx4 v10, s[40:43], s10 offen offset:2048 nt lds
    s_waitcnt vmcnt(3)
    buffer_load_dwordx4 v11, s[40:43], s10 offen offset:3072 nt lds
    s_branch L_pre_done
L_w17_role:
    s_waitcnt vmcnt(3)
    s_mov_b32 s10, s86
    buffer_load_dwordx4 v[156:159], v2, s[44:47], s10 offen offset:0 nt
    s_waitcnt vmcnt(3)
    buffer_load_dwordx4 v[160:163], v2, s[44:47], s10 offen offset:1024 nt
    s_waitcnt vmcnt(3)
    buffer_load_dwordx4 v[164:167], v2, s[44:47], s10 offen offset:2048 nt
    s_waitcnt vmcnt(3)
    buffer_load_dwordx4 v[168:171], v2, s[44:47], s10 offen offset:3072 nt
    s_waitcnt vmcnt(3)
    s_add_u32 s10, s10, 4096
    buffer_load_dwordx4 v[172:175], v2, s[44:47], s10 offen offset:0 nt
    s_waitcnt vmcnt(3)
    buffer_load_dwordx4 v[176:179], v2, s[44:47], s10 offen offset:1024 nt
    s_waitcnt vmcnt(3)
    buffer_load_dwordx4 v[180:183], v2, s[44:47], s10 offen offset:2048 nt
    s_waitcnt vmcnt(3)
    buffer_load_dwordx4 v[184:187], v2, s[44:47], s10 offen offset:3072 nt
L_role_w:
    s_cmp_eq_u32 s59, 0
    s_cbranch_scc1 L_pre_done
    v_lshrrev_b32 v4, 4, v1
    v_bfe_u32 v5, v1, 2, 2
    v_and_b32 v6, 3, v1
    v_lshlrev_b32 v6, 3, v6
    v_add_u32 v6, s60, v6
    v_lshl_add_u32 v7, v4, 3, v5
    s_cmp_eq_u32 s59, 3
    s_nop 0
    s_cbranch_scc1 L_trD
    v_lshl_add_u32 v6, v7, 7, v6
    v_lshrrev_b32 v5, 1, v5
    v_and_b32 v4, 1, v4
    v_lshl_add_u32 v5, v4, 1, v5
    v_xor_b32 v64, 0, v5
    v_lshl_add_u32 v64, v64, 5, v6
    v_xor_b32 v65, 1, v5
    v_lshl_add_u32 v65, v65, 5, v6
    v_xor_b32 v66, 2, v5
    v_lshl_add_u32 v66, v66, 5, v6
    v_xor_b32 v67, 3, v5
    v_lshl_add_u32 v67, v67, 5, v6
    s_waitcnt vmcnt(8)
    ds_read_b64_tr_b16 v[188:189], v64 offset:0
    ds_read_b64_tr_b16 v[190:191], v64 offset:512
    ds_read_b64_tr_b16 v[192:193], v64 offset:4096
    ds_read_b64_tr_b16 v[194:195], v64 offset:4608
    ds_read_b64_tr_b16 v[196:197], v64 offset:8192
    ds_read_b64_tr_b16 v[198:199], v64 offset:8704
    ds_read_b64_tr_b16 v[200:201], v64 offset:12288
    ds_read_b64_tr_b16 v[202:203], v64 offset:12800
    s_waitcnt lgkmcnt(0)
    ds_read_b64_tr_b16 v[204:205], v65 offset:0
    ds_read_b64_tr_b16 v[206:207], v65 offset:512
    ds_read_b64_tr_b16 v[208:209], v65 offset:4096
    ds_read_b64_tr_b16 v[210:211], v65 offset:4608
    ds_read_b64_tr_b16 v[212:213], v65 offset:8192
    ds_read_b64_tr_b16 v[214:215], v65 offset:8704
    ds_read_b64_tr_b16 v[216:217], v65 offset:12288
    ds_read_b64_tr_b16 v[218:219], v65 offset:12800
    s_waitcnt lgkmcnt(0)
    ds_read_b64_tr_b16 v[220:221], v66 offset:0
    ds_read_b64_tr_b16 v[222:223], v66 offset:512
    ds_read_b64_tr_b16 v[224:225], v66 offset:4096
    ds_read_b64_tr_b16 v[226:227], v66 offset:4608
    ds_read_b64_tr_b16 v[228:229], v66 offset:8192
    ds_read_b64_tr_b16 v[230:231], v66 offset:8704
    ds_read_b64_tr_b16 v[232:233], v66 offset:12288
    ds_read_b64_tr_b16 v[234:235], v66 offset:12800
    s_waitcnt lgkmcnt(0)
    ds_read_b64_tr_b16 v[236:237], v67 offset:0
    ds_read_b64_tr_b16 v[238:239], v67 offset:512
    ds_read_b64_tr_b16 v[240:241], v67 offset:4096
    ds_read_b64_tr_b16 v[242:243], v67 offset:4608
    ds_read_b64_tr_b16 v[244:245], v67 offset:8192
    ds_read_b64_tr_b16 v[246:247], v67 offset:8704
    ds_read_b64_tr_b16 v[248:249], v67 offset:12288
    ds_read_b64_tr_b16 v[250:251], v67 offset:12800
    s_waitcnt lgkmcnt(0)
    s_branch L_trdone
L_trD:
    v_lshl_add_u32 v6, v7, 6, v6
    v_and_b32 v4, 1, v4
    v_xor_b32 v64, 0, v4
    v_lshl_add_u32 v64, v64, 5, v6
    v_xor_b32 v65, 1, v4
    v_lshl_add_u32 v65, v65, 5, v6
    s_waitcnt vmcnt(8)
    ds_read_b64_tr_b16 v[188:189], v64 offset:0
    ds_read_b64_tr_b16 v[190:191], v64 offset:256
    ds_read_b64_tr_b16 v[192:193], v64 offset:2048
    ds_read_b64_tr_b16 v[194:195], v64 offset:2304
    ds_read_b64_tr_b16 v[196:197], v64 offset:4096
    ds_read_b64_tr_b16 v[198:199], v64 offset:4352
    ds_read_b64_tr_b16 v[200:201], v64 offset:6144
    ds_read_b64_tr_b16 v[202:203], v64 offset:6400
    ds_read_b64_tr_b16 v[204:205], v64 offset:8192
    ds_read_b64_tr_b16 v[206:207], v64 offset:8448
    ds_read_b64_tr_b16 v[208:209], v64 offset:10240
    ds_read_b64_tr_b16 v[210:211], v64 offset:10496
    ds_read_b64_tr_b16 v[212:213], v64 offset:12288
    ds_read_b64_tr_b16 v[214:215], v64 offset:12544
    s_waitcnt lgkmcnt(0)
    ds_read_b64_tr_b16 v[216:217], v65 offset:0
    ds_read_b64_tr_b16 v[218:219], v65 offset:256
    ds_read_b64_tr_b16 v[220:221], v65 offset:2048
    ds_read_b64_tr_b16 v[222:223], v65 offset:2304
    ds_read_b64_tr_b16 v[224:225], v65 offset:4096
    ds_read_b64_tr_b16 v[226:227], v65 offset:4352
    ds_read_b64_tr_b16 v[228:229], v65 offset:6144
    ds_read_b64_tr_b16 v[230:231], v65 offset:6400
    ds_read_b64_tr_b16 v[232:233], v65 offset:8192
    ds_read_b64_tr_b16 v[234:235], v65 offset:8448
    ds_read_b64_tr_b16 v[236:237], v65 offset:10240
    ds_read_b64_tr_b16 v[238:239], v65 offset:10496
    ds_read_b64_tr_b16 v[240:241], v65 offset:12288
    ds_read_b64_tr_b16 v[242:243], v65 offset:12544
    s_waitcnt lgkmcnt(0)
L_trdone:
    s_mov_b32 s10, s85
    s_add_u32 m0, s60, 0
    s_nop 0
    buffer_load_dwordx4 v8, s[40:43], s10 offen offset:0 nt lds
    buffer_load_dwordx4 v9, s[40:43], s10 offen offset:1024 nt lds
    buffer_load_dwordx4 v10, s[40:43], s10 offen offset:2048 nt lds
    buffer_load_dwordx4 v11, s[40:43], s10 offen offset:3072 nt lds
    s_add_u32 s10, s10, 4096
    s_add_u32 m0, s60, 4096
    s_nop 0
    buffer_load_dwordx4 v8, s[40:43], s10 offen offset:0 nt lds
    buffer_load_dwordx4 v9, s[40:43], s10 offen offset:1024 nt lds
    buffer_load_dwordx4 v10, s[40:43], s10 offen offset:2048 nt lds
    buffer_load_dwordx4 v11, s[40:43], s10 offen offset:3072 nt lds
    s_mov_b32 s10, s86
    s_add_u32 m0, s60, 8192
    s_nop 0
    buffer_load_dwordx4 v8, s[40:43], s10 offen offset:0 nt lds
    buffer_load_dwordx4 v9, s[40:43], s10 offen offset:1024 nt lds
    buffer_load_dwordx4 v10, s[40:43], s10 offen offset:2048 nt lds
    buffer_load_dwordx4 v11, s[40:43], s10 offen offset:3072 nt lds
    s_add_u32 s10, s10, 4096
    s_add_u32 m0, s60, 12288
    s_nop 0
    buffer_load_dwordx4 v8, s[40:43], s10 offen offset:0 nt lds
    buffer_load_dwordx4 v9, s[40:43], s10 offen offset:1024 nt lds
    buffer_load_dwordx4 v10, s[40:43], s10 offen offset:2048 nt lds
    buffer_load_dwordx4 v11, s[40:43], s10 offen offset:3072 nt lds
L_pre_done:
    v_mov_b32 v6, 149248
    s_mov_b32 s57, 1000000
    s_nop 0
L_qf:
    ds_read_b32 v7, v6
    s_sub_u32 s57, s57, 1
    s_waitcnt lgkmcnt(0)
    v_readfirstlane_b32 s58, v7
    s_cmp_eq_u32 s57, 0
    s_nop 3
    s_cbranch_scc1 L_haveq
    s_cmp_eq_u32 s58, 1
    s_cbranch_scc1 L_haveq
    s_sleep 2
    s_branch L_qf
L_haveq:
    v_and_b32 v6, 3, v1
    v_lshlrev_b32 v6, 8, v6
    v_add_u32 v6, v6, v3
    v_add_u32 v6, 147712, v6
    ds_read_b128 v[16:19], v6 offset:0
    ds_read_b128 v[20:23], v6 offset:64
    ds_read_b128 v[24:27], v6 offset:128
    ds_read_b128 v[28:31], v6 offset:192
    v_mov_b32 v32, 0
    v_mov_b32 v33, 0
    v_mov_b32 v34, 0
    v_mov_b32 v35, 0
    v_mov_b32 v36, 0
    v_mov_b32 v37, 0
    v_mov_b32 v38, 0
    v_mov_b32 v39, 0
    v_mov_b32 v40, 0
    v_mov_b32 v41, 0
    v_mov_b32 v42, 0
    v_mov_b32 v43, 0
    v_mov_b32 v44, 0
    v_mov_b32 v45, 0
    v_mov_b32 v46, 0
    v_mov_b32 v47, 0
    v_mov_b32 v48, 0
    v_mov_b32 v49, 0
    v_mov_b32 v50, 0
    v_mov_b32 v51, 0
    v_mov_b32 v52, 0
    v_mov_b32 v53, 0
    v_mov_b32 v54, 0
    v_mov_b32 v55, 0
    v_mov_b32 v56, 0
    v_mov_b32 v57, 0
    v_mov_b32 v58, 0
    v_mov_b32 v59, 0
    v_mov_b32 v60, 0
    v_mov_b32 v61, 0
    v_mov_b32 v62, 0
    v_mov_b32 v63, 0
    v_mov_b32 v108, 0xff800000
    v_mov_b32 v109, 0
    v_mov_b32 v4, 0
    s_mov_b32 s11, 0x3db504f3
    s_mov_b32 s12, 0x3fb8aa3b
    s_mov_b32 s13, 0x05040100
    s_mov_b32 s14, 0x07060302
    s_add_u32 s65, s3, s5
    s_and_b32 s65, s65, 1
    s_add_u32 s65, s65, 560
    s_cmp_eq_u32 s91, 2
    s_cbranch_scc1 L_loop_done
    s_waitcnt vmcnt(8) lgkmcnt(0)
    ds_read_b128 v[64:67], v12 offset:0
    ds_read_b128 v[68:71], v13 offset:0
    ds_read_b128 v[72:75], v14 offset:0
    ds_read_b128 v[76:79], v15 offset:0
    ds_read_b128 v[80:83], v12 offset:4096
    ds_read_b128 v[84:87], v13 offset:4096
    ds_read_b128 v[88:91], v14 offset:4096
    ds_read_b128 v[92:95], v15 offset:4096
    s_waitcnt lgkmcnt(7)
    v_mfma_f32_16x16x32_bf16 v[96:99], v[64:67], v[16:19], 0
    s_waitcnt lgkmcnt(6)
    v_mfma_f32_16x16x32_bf16 v[96:99], v[68:71], v[20:23], v[96:99]
    s_waitcnt lgkmcnt(5)
    v_mfma_f32_16x16x32_bf16 v[96:99], v[72:75], v[24:27], v[96:99]
    s_waitcnt lgkmcnt(4)
    v_mfma_f32_16x16x32_bf16 v[96:99], v[76:79], v[28:31], v[96:99]
    s_waitcnt lgkmcnt(3)
    v_mfma_f32_16x16x32_bf16 v[100:103], v[80:83], v[16:19], 0
    s_waitcnt lgkmcnt(2)
    v_mfma_f32_16x16x32_bf16 v[100:103], v[84:87], v[20:23], v[100:103]
    s_waitcnt lgkmcnt(1)
    v_mfma_f32_16x16x32_bf16 v[100:103], v[88:91], v[24:27], v[100:103]
    s_waitcnt lgkmcnt(0)
    v_mfma_f32_16x16x32_bf16 v[100:103], v[92:95], v[28:31], v[100:103]
    s_mov_b32 s10, s87
    s_add_u32 m0, s60, 0
    s_nop 0
    buffer_load_dwordx4 v8, s[40:43], s10 offen offset:0 nt lds
    buffer_load_dwordx4 v9, s[40:43], s10 offen offset:1024 nt lds
    buffer_load_dwordx4 v10, s[40:43], s10 offen offset:2048 nt lds
    buffer_load_dwordx4 v11, s[40:43], s10 offen offset:3072 nt lds
    s_add_u32 s10, s10, 4096
    s_add_u32 m0, s60, 4096
    s_nop 0
    buffer_load_dwordx4 v8, s[40:43], s10 offen offset:0 nt lds
    buffer_load_dwordx4 v9, s[40:43], s10 offen offset:1024 nt lds
    buffer_load_dwordx4 v10, s[40:43], s10 offen offset:2048 nt lds
    buffer_load_dwordx4 v11, s[40:43], s10 offen offset:3072 nt lds
    v_mov_b32 v115, 0x7fffffff
    s_cmp_ge_u32 s3, 4
    s_nop 0
    s_cbranch_scc1 L_notk
    v_mov_b32 v115, 1
    s_mov_b64 exec, 1
    buffer_atomic_add v115, v4, s[52:55], s62 offen sc0
    s_mov_b64 exec, -1
L_notk:
    v_cvt_pk_bf16_f32 v110, v96, v97
    v_lshlrev_b32 v111, 16, v110
    v_and_b32 v112, 0xffff0000, v110
    v_mul_f32 v111, s11, v111
    v_mul_f32 v112, s11, v112
    v_cvt_pk_bf16_f32 v110, v111, v112
    v_lshlrev_b32 v116, 16, v110
    v_and_b32 v117, 0xffff0000, v110
    v_cvt_pk_bf16_f32 v110, v98, v99
    v_lshlrev_b32 v111, 16, v110
    v_and_b32 v112, 0xffff0000, v110
    v_mul_f32 v111, s11, v111
    v_mul_f32 v112, s11, v112
    v_cvt_pk_bf16_f32 v110, v111, v112
    v_lshlrev_b32 v118, 16, v110
    v_and_b32 v119, 0xffff0000, v110
    v_cvt_pk_bf16_f32 v110, v100, v101
    v_lshlrev_b32 v111, 16, v110
    v_and_b32 v112, 0xffff0000, v110
    v_mul_f32 v111, s11, v111
    v_mul_f32 v112, s11, v112
    v_cvt_pk_bf16_f32 v110, v111, v112
    v_lshlrev_b32 v120, 16, v110
    v_and_b32 v121, 0xffff0000, v110
    v_cvt_pk_bf16_f32 v110, v102, v103
    v_lshlrev_b32 v111, 16, v110
    v_and_b32 v112, 0xffff0000, v110
    v_mul_f32 v111, s11, v111
    v_mul_f32 v112, s11, v112
    v_cvt_pk_bf16_f32 v110, v111, v112
    v_lshlrev_b32 v122, 16, v110
    v_and_b32 v123, 0xffff0000, v110
    v_max3_f32 v111, v116, v117, v118
    v_max3_f32 v112, v119, v120, v121
    v_max3_f32 v111, v111, v122, v123
    v_max3_f32 v111, v111, v112, v108
    v_mov_b32 v110, v111
    s_nop 1
    v_permlane16_swap_b32 v110, v111
    v_max_f32 v111, v110, v111
    v_mov_b32 v110, v111
    s_nop 1
    v_permlane32_swap_b32 v110, v111
    v_max_f32 v111, v110, v111
    v_sub_f32 v112, v108, v111
    v_mul_f32 v113, s12, v111
    v_mul_f32 v112, s12, v112
    v_mov_b32 v108, v111
    v_exp_f32 v112, v112
    v_fma_f32 v116, v116, s12, -v113
    v_fma_f32 v117, v117, s12, -v113
    v_fma_f32 v118, v118, s12, -v113
    v_fma_f32 v119, v119, s12, -v113
    v_fma_f32 v120, v120, s12, -v113
    v_fma_f32 v121, v121, s12, -v113
    v_fma_f32 v122, v122, s12, -v113
    v_fma_f32 v123, v123, s12, -v113
    v_exp_f32 v116, v116
    v_exp_f32 v117, v117
    v_exp_f32 v118, v118
    v_exp_f32 v119, v119
    v_exp_f32 v120, v120
    v_exp_f32 v121, v121
    v_exp_f32 v122, v122
    v_exp_f32 v123, v123
    v_mul_f32 v109, v109, v112
    v_mul_f32 v32, v112, v32
    v_mul_f32 v33, v112, v33
    v_mul_f32 v34, v112, v34
    v_mul_f32 v35, v112, v35
    v_mul_f32 v36, v112, v36
    v_mul_f32 v37, v112, v37
    v_mul_f32 v38, v112, v38
    v_mul_f32 v39, v112, v39
    v_mul_f32 v40, v112, v40
    v_mul_f32 v41, v112, v41
    v_mul_f32 v42, v112, v42
    v_mul_f32 v43, v112, v43
    v_mul_f32 v44, v112, v44
    v_mul_f32 v45, v112, v45
    v_mul_f32 v46, v112, v46
    v_mul_f32 v47, v112, v47
    v_mul_f32 v48, v112, v48
    v_mul_f32 v49, v112, v49
    v_mul_f32 v50, v112, v50
    v_mul_f32 v51, v112, v51
    v_mul_f32 v52, v112, v52
    v_mul_f32 v53, v112, v53
    v_mul_f32 v54, v112, v54
    v_mul_f32 v55, v112, v55
    v_mul_f32 v56, v112, v56
    v_mul_f32 v57, v112, v57
    v_mul_f32 v58, v112, v58
    v_mul_f32 v59, v112, v59
    v_mul_f32 v60, v112, v60
    v_mul_f32 v61, v112, v61
    v_mul_f32 v62, v112, v62
    v_mul_f32 v63, v112, v63
    v_cvt_pk_bf16_f32 v104, v116, v117
    v_cvt_pk_bf16_f32 v105, v118, v119
    v_cvt_pk_bf16_f32 v106, v120, v121
    v_cvt_pk_bf16_f32 v107, v122, v123
    v_add_f32 v109, v109, v116
    v_add_f32 v109, v109, v117
    v_add_f32 v109, v109, v118
    v_add_f32 v109, v109, v119
    v_add_f32 v109, v109, v120
    v_add_f32 v109, v109, v121
    v_add_f32 v109, v109, v122
    v_add_f32 v109, v109, v123
    v_perm_b32 v80, v128, v124, s13
    v_perm_b32 v84, v128, v124, s14
    v_perm_b32 v81, v136, v132, s13
    v_perm_b32 v85, v136, v132, s14
    v_perm_b32 v82, v144, v140, s13
    v_perm_b32 v86, v144, v140, s14
    v_perm_b32 v83, v152, v148, s13
    v_perm_b32 v87, v152, v148, s14
    s_nop 0
    v_mfma_f32_16x16x32_bf16 v[32:35], v[80:83], v[104:107], v[32:35]
    v_mfma_f32_16x16x32_bf16 v[36:39], v[84:87], v[104:107], v[36:39]
    v_perm_b32 v88, v129, v125, s13
    v_perm_b32 v92, v129, v125, s14
    v_perm_b32 v89, v137, v133, s13
    v_perm_b32 v93, v137, v133, s14
    v_perm_b32 v90, v145, v141, s13
    v_perm_b32 v94, v145, v141, s14
    v_perm_b32 v91, v153, v149, s13
    v_perm_b32 v95, v153, v149, s14
    s_nop 0
    v_mfma_f32_16x16x32_bf16 v[40:43], v[88:91], v[104:107], v[40:43]
    v_mfma_f32_16x16x32_bf16 v[44:47], v[92:95], v[104:107], v[44:47]
    v_perm_b32 v80, v130, v126, s13
    v_perm_b32 v84, v130, v126, s14
    v_perm_b32 v81, v138, v134, s13
    v_perm_b32 v85, v138, v134, s14
    v_perm_b32 v82, v146, v142, s13
    v_perm_b32 v86, v146, v142, s14
    v_perm_b32 v83, v154, v150, s13
    v_perm_b32 v87, v154, v150, s14
    s_nop 0
    v_mfma_f32_16x16x32_bf16 v[48:51], v[80:83], v[104:107], v[48:51]
    v_mfma_f32_16x16x32_bf16 v[52:55], v[84:87], v[104:107], v[52:55]
    v_perm_b32 v88, v131, v127, s13
    v_perm_b32 v92, v131, v127, s14
    v_perm_b32 v89, v139, v135, s13
    v_perm_b32 v93, v139, v135, s14
    v_perm_b32 v90, v147, v143, s13
    v_perm_b32 v94, v147, v143, s14
    v_perm_b32 v91, v155, v151, s13
    v_perm_b32 v95, v155, v151, s14
    s_nop 0
    v_mfma_f32_16x16x32_bf16 v[56:59], v[88:91], v[104:107], v[56:59]
    v_mfma_f32_16x16x32_bf16 v[60:63], v[92:95], v[104:107], v[60:63]
    s_mov_b32 s10, s87
    buffer_load_dwordx4 v[124:127], v2, s[44:47], s10 offen offset:0 nt
    buffer_load_dwordx4 v[128:131], v2, s[44:47], s10 offen offset:1024 nt
    buffer_load_dwordx4 v[132:135], v2, s[44:47], s10 offen offset:2048 nt
    buffer_load_dwordx4 v[136:139], v2, s[44:47], s10 offen offset:3072 nt
    s_add_u32 s10, s10, 4096
    buffer_load_dwordx4 v[140:143], v2, s[44:47], s10 offen offset:0 nt
    buffer_load_dwordx4 v[144:147], v2, s[44:47], s10 offen offset:1024 nt
    buffer_load_dwordx4 v[148:151], v2, s[44:47], s10 offen offset:2048 nt
    buffer_load_dwordx4 v[152:155], v2, s[44:47], s10 offen offset:3072 nt
    s_setprio 0
    s_waitcnt vmcnt(16)
    s_cmp_lg_u32 s3, 0
    s_cbranch_scc1 L_noflag
    v_mov_b32 v110, 1
    s_mov_b64 exec, 1
    buffer_store_byte v110, v4, s[48:51], s2 offen sc1
    s_mov_b64 exec, -1
L_noflag:
    ds_read_b128 v[64:67], v12 offset:8192
    ds_read_b128 v[68:71], v13 offset:8192
    ds_read_b128 v[72:75], v14 offset:8192
    ds_read_b128 v[76:79], v15 offset:8192
    ds_read_b128 v[80:83], v12 offset:12288
    ds_read_b128 v[84:87], v13 offset:12288
    ds_read_b128 v[88:91], v14 offset:12288
    ds_read_b128 v[92:95], v15 offset:12288
    s_waitcnt lgkmcnt(7)
    v_mfma_f32_16x16x32_bf16 v[96:99], v[64:67], v[16:19], 0
    s_waitcnt lgkmcnt(6)
    v_mfma_f32_16x16x32_bf16 v[96:99], v[68:71], v[20:23], v[96:99]
    s_waitcnt lgkmcnt(5)
    v_mfma_f32_16x16x32_bf16 v[96:99], v[72:75], v[24:27], v[96:99]
    s_waitcnt lgkmcnt(4)
    v_mfma_f32_16x16x32_bf16 v[96:99], v[76:79], v[28:31], v[96:99]
    s_waitcnt lgkmcnt(3)
    v_mfma_f32_16x16x32_bf16 v[100:103], v[80:83], v[16:19], 0
    s_waitcnt lgkmcnt(2)
    v_mfma_f32_16x16x32_bf16 v[100:103], v[84:87], v[20:23], v[100:103]
    s_waitcnt lgkmcnt(1)
    v_mfma_f32_16x16x32_bf16 v[100:103], v[88:91], v[24:27], v[100:103]
    s_waitcnt lgkmcnt(0)
    v_mfma_f32_16x16x32_bf16 v[100:103], v[92:95], v[28:31], v[100:103]
    v_cvt_pk_bf16_f32 v110, v96, v97
    v_lshlrev_b32 v111, 16, v110
    v_and_b32 v112, 0xffff0000, v110
    v_mul_f32 v111, s11, v111
    v_mul_f32 v112, s11, v112
    v_cvt_pk_bf16_f32 v110, v111, v112
    v_lshlrev_b32 v116, 16, v110
    v_and_b32 v117, 0xffff0000, v110
    v_cvt_pk_bf16_f32 v110, v98, v99
    v_lshlrev_b32 v111, 16, v110
    v_and_b32 v112, 0xffff0000, v110
    v_mul_f32 v111, s11, v111
    v_mul_f32 v112, s11, v112
    v_cvt_pk_bf16_f32 v110, v111, v112
    v_lshlrev_b32 v118, 16, v110
    v_and_b32 v119, 0xffff0000, v110
    v_cvt_pk_bf16_f32 v110, v100, v101
    v_lshlrev_b32 v111, 16, v110
    v_and_b32 v112, 0xffff0000, v110
    v_mul_f32 v111, s11, v111
    v_mul_f32 v112, s11, v112
    v_cvt_pk_bf16_f32 v110, v111, v112
    v_lshlrev_b32 v120, 16, v110
    v_and_b32 v121, 0xffff0000, v110
    v_cvt_pk_bf16_f32 v110, v102, v103
    v_lshlrev_b32 v111, 16, v110
    v_and_b32 v112, 0xffff0000, v110
    v_mul_f32 v111, s11, v111
    v_mul_f32 v112, s11, v112
    v_cvt_pk_bf16_f32 v110, v111, v112
    v_lshlrev_b32 v122, 16, v110
    v_and_b32 v123, 0xffff0000, v110
    v_max3_f32 v111, v116, v117, v118
    v_max3_f32 v112, v119, v120, v121
    v_max3_f32 v111, v111, v122, v123
    v_max3_f32 v111, v111, v112, v108
    v_mov_b32 v110, v111
    s_nop 1
    v_permlane16_swap_b32 v110, v111
    v_max_f32 v111, v110, v111
    v_mov_b32 v110, v111
    s_nop 1
    v_permlane32_swap_b32 v110, v111
    v_max_f32 v111, v110, v111
    v_sub_f32 v112, v108, v111
    v_mul_f32 v113, s12, v111
    v_mul_f32 v112, s12, v112
    v_mov_b32 v108, v111
    v_exp_f32 v112, v112
    v_fma_f32 v116, v116, s12, -v113
    v_fma_f32 v117, v117, s12, -v113
    v_fma_f32 v118, v118, s12, -v113
    v_fma_f32 v119, v119, s12, -v113
    v_fma_f32 v120, v120, s12, -v113
    v_fma_f32 v121, v121, s12, -v113
    v_fma_f32 v122, v122, s12, -v113
    v_fma_f32 v123, v123, s12, -v113
    v_exp_f32 v116, v116
    v_exp_f32 v117, v117
    v_exp_f32 v118, v118
    v_exp_f32 v119, v119
    v_exp_f32 v120, v120
    v_exp_f32 v121, v121
    v_exp_f32 v122, v122
    v_exp_f32 v123, v123
    v_mul_f32 v109, v109, v112
    v_mul_f32 v32, v112, v32
    v_mul_f32 v33, v112, v33
    v_mul_f32 v34, v112, v34
    v_mul_f32 v35, v112, v35
    v_mul_f32 v36, v112, v36
    v_mul_f32 v37, v112, v37
    v_mul_f32 v38, v112, v38
    v_mul_f32 v39, v112, v39
    v_mul_f32 v40, v112, v40
    v_mul_f32 v41, v112, v41
    v_mul_f32 v42, v112, v42
    v_mul_f32 v43, v112, v43
    v_mul_f32 v44, v112, v44
    v_mul_f32 v45, v112, v45
    v_mul_f32 v46, v112, v46
    v_mul_f32 v47, v112, v47
    v_mul_f32 v48, v112, v48
    v_mul_f32 v49, v112, v49
    v_mul_f32 v50, v112, v50
    v_mul_f32 v51, v112, v51
    v_mul_f32 v52, v112, v52
    v_mul_f32 v53, v112, v53
    v_mul_f32 v54, v112, v54
    v_mul_f32 v55, v112, v55
    v_mul_f32 v56, v112, v56
    v_mul_f32 v57, v112, v57
    v_mul_f32 v58, v112, v58
    v_mul_f32 v59, v112, v59
    v_mul_f32 v60, v112, v60
    v_mul_f32 v61, v112, v61
    v_mul_f32 v62, v112, v62
    v_mul_f32 v63, v112, v63
    v_cvt_pk_bf16_f32 v104, v116, v117
    v_cvt_pk_bf16_f32 v105, v118, v119
    v_cvt_pk_bf16_f32 v106, v120, v121
    v_cvt_pk_bf16_f32 v107, v122, v123
    v_add_f32 v109, v109, v116
    v_add_f32 v109, v109, v117
    v_add_f32 v109, v109, v118
    v_add_f32 v109, v109, v119
    v_add_f32 v109, v109, v120
    v_add_f32 v109, v109, v121
    v_add_f32 v109, v109, v122
    v_add_f32 v109, v109, v123
    v_perm_b32 v80, v160, v156, s13
    v_perm_b32 v84, v160, v156, s14
    v_perm_b32 v81, v168, v164, s13
    v_perm_b32 v85, v168, v164, s14
    v_perm_b32 v82, v176, v172, s13
    v_perm_b32 v86, v176, v172, s14
    v_perm_b32 v83, v184, v180, s13
    v_perm_b32 v87, v184, v180, s14
    s_nop 0
    v_mfma_f32_16x16x32_bf16 v[32:35], v[80:83], v[104:107], v[32:35]
    v_mfma_f32_16x16x32_bf16 v[36:39], v[84:87], v[104:107], v[36:39]
    v_perm_b32 v88, v161, v157, s13
    v_perm_b32 v92, v161, v157, s14
    v_perm_b32 v89, v169, v165, s13
    v_perm_b32 v93, v169, v165, s14
    v_perm_b32 v90, v177, v173, s13
    v_perm_b32 v94, v177, v173, s14
    v_perm_b32 v91, v185, v181, s13
    v_perm_b32 v95, v185, v181, s14
    s_nop 0
    v_mfma_f32_16x16x32_bf16 v[40:43], v[88:91], v[104:107], v[40:43]
    v_mfma_f32_16x16x32_bf16 v[44:47], v[92:95], v[104:107], v[44:47]
    v_perm_b32 v80, v162, v158, s13
    v_perm_b32 v84, v162, v158, s14
    v_perm_b32 v81, v170, v166, s13
    v_perm_b32 v85, v170, v166, s14
    v_perm_b32 v82, v178, v174, s13
    v_perm_b32 v86, v178, v174, s14
    v_perm_b32 v83, v186, v182, s13
    v_perm_b32 v87, v186, v182, s14
    s_nop 0
    v_mfma_f32_16x16x32_bf16 v[48:51], v[80:83], v[104:107], v[48:51]
    v_mfma_f32_16x16x32_bf16 v[52:55], v[84:87], v[104:107], v[52:55]
    v_perm_b32 v88, v163, v159, s13
    v_perm_b32 v92, v163, v159, s14
    v_perm_b32 v89, v171, v167, s13
    v_perm_b32 v93, v171, v167, s14
    v_perm_b32 v90, v179, v175, s13
    v_perm_b32 v94, v179, v175, s14
    v_perm_b32 v91, v187, v183, s13
    v_perm_b32 v95, v187, v183, s14
    s_nop 0
    v_mfma_f32_16x16x32_bf16 v[56:59], v[88:91], v[104:107], v[56:59]
    v_mfma_f32_16x16x32_bf16 v[60:63], v[92:95], v[104:107], v[60:63]
    s_cmp_eq_u32 s91, 1
    s_nop 6
    s_cbranch_scc1 L_loop_done
    s_mov_b32 s72, 0
    s_mov_b32 s73, 0
    s_movk_i32 s66, 600
L_loop:
    s_waitcnt vmcnt(8)
    ds_read_b128 v[64:67], v12 offset:0
    ds_read_b128 v[68:71], v13 offset:0
    ds_read_b128 v[72:75], v14 offset:0
    ds_read_b128 v[76:79], v15 offset:0
    ds_read_b128 v[80:83], v12 offset:4096
    ds_read_b128 v[84:87], v13 offset:4096
    ds_read_b128 v[88:91], v14 offset:4096
    ds_read_b128 v[92:95], v15 offset:4096
    v_readfirstlane_b32 s61, v115
    s_nop 0
    s_cmp_lt_u32 s61, 744
    s_cselect_b32 s63, 1, 0
    s_nop 1
    s_cbranch_scc0 L_noissue0
    s_lshl_b32 s61, s61, 1
    s_add_u32 s61, s61, s65
    s_lshl_b32 s61, s61, 13
    s_add_u32 s61, s61, s67
    s_and_b32 s61, s61, 0xffffff
    s_mov_b32 s10, s61
    s_add_u32 m0, s60, 8192
    s_nop 0
    buffer_load_dwordx4 v8, s[40:43], s10 offen offset:0 nt lds
    buffer_load_dwordx4 v9, s[40:43], s10 offen offset:1024 nt lds
    buffer_load_dwordx4 v10, s[40:43], s10 offen offset:2048 nt lds
    buffer_load_dwordx4 v11, s[40:43], s10 offen offset:3072 nt lds
    s_add_u32 s10, s10, 4096
    s_add_u32 m0, s60, 12288
    s_nop 0
    buffer_load_dwordx4 v8, s[40:43], s10 offen offset:0 nt lds
    buffer_load_dwordx4 v9, s[40:43], s10 offen offset:1024 nt lds
    buffer_load_dwordx4 v10, s[40:43], s10 offen offset:2048 nt lds
    buffer_load_dwordx4 v11, s[40:43], s10 offen offset:3072 nt lds
L_noissue0:
    s_waitcnt lgkmcnt(7)
    v_mfma_f32_16x16x32_bf16 v[96:99], v[64:67], v[16:19], 0
    s_waitcnt lgkmcnt(6)
    v_mfma_f32_16x16x32_bf16 v[96:99], v[68:71], v[20:23], v[96:99]
    s_waitcnt lgkmcnt(5)
    v_mfma_f32_16x16x32_bf16 v[96:99], v[72:75], v[24:27], v[96:99]
    s_waitcnt lgkmcnt(4)
    v_mfma_f32_16x16x32_bf16 v[96:99], v[76:79], v[28:31], v[96:99]
    s_waitcnt lgkmcnt(3)
    v_mfma_f32_16x16x32_bf16 v[100:103], v[80:83], v[16:19], 0
    s_waitcnt lgkmcnt(2)
    v_mfma_f32_16x16x32_bf16 v[100:103], v[84:87], v[20:23], v[100:103]
    s_waitcnt lgkmcnt(1)
    v_mfma_f32_16x16x32_bf16 v[100:103], v[88:91], v[24:27], v[100:103]
    s_waitcnt lgkmcnt(0)
    v_mfma_f32_16x16x32_bf16 v[100:103], v[92:95], v[28:31], v[100:103]
    v_cvt_pk_bf16_f32 v110, v96, v97
    v_lshlrev_b32 v111, 16, v110
    v_and_b32 v112, 0xffff0000, v110
    v_mul_f32 v111, s11, v111
    v_mul_f32 v112, s11, v112
    v_cvt_pk_bf16_f32 v110, v111, v112
    v_lshlrev_b32 v116, 16, v110
    v_and_b32 v117, 0xffff0000, v110
    v_cvt_pk_bf16_f32 v110, v98, v99
    v_lshlrev_b32 v111, 16, v110
    v_and_b32 v112, 0xffff0000, v110
    v_mul_f32 v111, s11, v111
    v_mul_f32 v112, s11, v112
    v_cvt_pk_bf16_f32 v110, v111, v112
    v_lshlrev_b32 v118, 16, v110
    v_and_b32 v119, 0xffff0000, v110
    v_cvt_pk_bf16_f32 v110, v100, v101
    v_lshlrev_b32 v111, 16, v110
    v_and_b32 v112, 0xffff0000, v110
    v_mul_f32 v111, s11, v111
    v_mul_f32 v112, s11, v112
    v_cvt_pk_bf16_f32 v110, v111, v112
    v_lshlrev_b32 v120, 16, v110
    v_and_b32 v121, 0xffff0000, v110
    v_cvt_pk_bf16_f32 v110, v102, v103
    v_lshlrev_b32 v111, 16, v110
    v_and_b32 v112, 0xffff0000, v110
    v_mul_f32 v111, s11, v111
    v_mul_f32 v112, s11, v112
    v_cvt_pk_bf16_f32 v110, v111, v112
    v_lshlrev_b32 v122, 16, v110
    v_and_b32 v123, 0xffff0000, v110
    v_max3_f32 v111, v116, v117, v118
    v_max3_f32 v112, v119, v120, v121
    v_max3_f32 v111, v111, v122, v123
    v_max3_f32 v111, v111, v112, v108
    v_mov_b32 v110, v111
    s_nop 1
    v_permlane16_swap_b32 v110, v111
    v_max_f32 v111, v110, v111
    v_mov_b32 v110, v111
    s_nop 1
    v_permlane32_swap_b32 v110, v111
    v_max_f32 v111, v110, v111
    v_sub_f32 v112, v108, v111
    v_mul_f32 v113, s12, v111
    v_mul_f32 v112, s12, v112
    v_mov_b32 v108, v111
    v_exp_f32 v112, v112
    v_fma_f32 v116, v116, s12, -v113
    v_fma_f32 v117, v117, s12, -v113
    v_fma_f32 v118, v118, s12, -v113
    v_fma_f32 v119, v119, s12, -v113
    v_fma_f32 v120, v120, s12, -v113
    v_fma_f32 v121, v121, s12, -v113
    v_fma_f32 v122, v122, s12, -v113
    v_fma_f32 v123, v123, s12, -v113
    v_exp_f32 v116, v116
    v_exp_f32 v117, v117
    v_exp_f32 v118, v118
    v_exp_f32 v119, v119
    v_exp_f32 v120, v120
    v_exp_f32 v121, v121
    v_exp_f32 v122, v122
    v_exp_f32 v123, v123
    v_mul_f32 v109, v109, v112
    v_mul_f32 v32, v112, v32
    v_mul_f32 v33, v112, v33
    v_mul_f32 v34, v112, v34
    v_mul_f32 v35, v112, v35
    v_mul_f32 v36, v112, v36
    v_mul_f32 v37, v112, v37
    v_mul_f32 v38, v112, v38
    v_mul_f32 v39, v112, v39
    v_mul_f32 v40, v112, v40
    v_mul_f32 v41, v112, v41
    v_mul_f32 v42, v112, v42
    v_mul_f32 v43, v112, v43
    v_mul_f32 v44, v112, v44
    v_mul_f32 v45, v112, v45
    v_mul_f32 v46, v112, v46
    v_mul_f32 v47, v112, v47
    v_mul_f32 v48, v112, v48
    v_mul_f32 v49, v112, v49
    v_mul_f32 v50, v112, v50
    v_mul_f32 v51, v112, v51
    v_mul_f32 v52, v112, v52
    v_mul_f32 v53, v112, v53
    v_mul_f32 v54, v112, v54
    v_mul_f32 v55, v112, v55
    v_mul_f32 v56, v112, v56
    v_mul_f32 v57, v112, v57
    v_mul_f32 v58, v112, v58
    v_mul_f32 v59, v112, v59
    v_mul_f32 v60, v112, v60
    v_mul_f32 v61, v112, v61
    v_mul_f32 v62, v112, v62
    v_mul_f32 v63, v112, v63
    v_cvt_pk_bf16_f32 v104, v116, v117
    v_cvt_pk_bf16_f32 v105, v118, v119
    v_cvt_pk_bf16_f32 v106, v120, v121
    v_cvt_pk_bf16_f32 v107, v122, v123
    v_add_f32 v109, v109, v116
    v_add_f32 v109, v109, v117
    v_add_f32 v109, v109, v118
    v_add_f32 v109, v109, v119
    v_add_f32 v109, v109, v120
    v_add_f32 v109, v109, v121
    v_add_f32 v109, v109, v122
    v_add_f32 v109, v109, v123
    s_cmp_eq_u32 s63, 1
    s_nop 0
    s_cbranch_scc1 L_norm0
    s_waitcnt vmcnt(0)
    s_branch L_pv0
L_norm0:
    s_waitcnt vmcnt(8)
    v_mov_b32 v115, 1
    s_mov_b64 exec, 1
    buffer_atomic_add v115, v4, s[52:55], s62 offen sc0
    s_mov_b64 exec, -1
    s_mov_b32 s10, s61
    buffer_load_dwordx4 v[156:159], v2, s[44:47], s10 offen offset:0 nt
    buffer_load_dwordx4 v[160:163], v2, s[44:47], s10 offen offset:1024 nt
    buffer_load_dwordx4 v[164:167], v2, s[44:47], s10 offen offset:2048 nt
    buffer_load_dwordx4 v[168:171], v2, s[44:47], s10 offen offset:3072 nt
    s_add_u32 s10, s10, 4096
    buffer_load_dwordx4 v[172:175], v2, s[44:47], s10 offen offset:0 nt
    buffer_load_dwordx4 v[176:179], v2, s[44:47], s10 offen offset:1024 nt
    buffer_load_dwordx4 v[180:183], v2, s[44:47], s10 offen offset:2048 nt
    buffer_load_dwordx4 v[184:187], v2, s[44:47], s10 offen offset:3072 nt
L_pv0:
    v_perm_b32 v80, v128, v124, s13
    v_perm_b32 v84, v128, v124, s14
    v_perm_b32 v81, v136, v132, s13
    v_perm_b32 v85, v136, v132, s14
    v_perm_b32 v82, v144, v140, s13
    v_perm_b32 v86, v144, v140, s14
    v_perm_b32 v83, v152, v148, s13
    v_perm_b32 v87, v152, v148, s14
    s_nop 0
    v_mfma_f32_16x16x32_bf16 v[32:35], v[80:83], v[104:107], v[32:35]
    v_mfma_f32_16x16x32_bf16 v[36:39], v[84:87], v[104:107], v[36:39]
    v_perm_b32 v88, v129, v125, s13
    v_perm_b32 v92, v129, v125, s14
    v_perm_b32 v89, v137, v133, s13
    v_perm_b32 v93, v137, v133, s14
    v_perm_b32 v90, v145, v141, s13
    v_perm_b32 v94, v145, v141, s14
    v_perm_b32 v91, v153, v149, s13
    v_perm_b32 v95, v153, v149, s14
    s_nop 0
    v_mfma_f32_16x16x32_bf16 v[40:43], v[88:91], v[104:107], v[40:43]
    v_mfma_f32_16x16x32_bf16 v[44:47], v[92:95], v[104:107], v[44:47]
    v_perm_b32 v80, v130, v126, s13
    v_perm_b32 v84, v130, v126, s14
    v_perm_b32 v81, v138, v134, s13
    v_perm_b32 v85, v138, v134, s14
    v_perm_b32 v82, v146, v142, s13
    v_perm_b32 v86, v146, v142, s14
    v_perm_b32 v83, v154, v150, s13
    v_perm_b32 v87, v154, v150, s14
    s_nop 0
    v_mfma_f32_16x16x32_bf16 v[48:51], v[80:83], v[104:107], v[48:51]
    v_mfma_f32_16x16x32_bf16 v[52:55], v[84:87], v[104:107], v[52:55]
    v_perm_b32 v88, v131, v127, s13
    v_perm_b32 v92, v131, v127, s14
    v_perm_b32 v89, v139, v135, s13
    v_perm_b32 v93, v139, v135, s14
    v_perm_b32 v90, v147, v143, s13
    v_perm_b32 v94, v147, v143, s14
    v_perm_b32 v91, v155, v151, s13
    v_perm_b32 v95, v155, v151, s14
    s_nop 0
    v_mfma_f32_16x16x32_bf16 v[56:59], v[88:91], v[104:107], v[56:59]
    v_mfma_f32_16x16x32_bf16 v[60:63], v[92:95], v[104:107], v[60:63]
    s_cmp_eq_u32 s63, 0
    s_nop 6
    s_cbranch_scc1 L_loop_done
    s_waitcnt vmcnt(8)
    ds_read_b128 v[64:67], v12 offset:8192
    ds_read_b128 v[68:71], v13 offset:8192
    ds_read_b128 v[72:75], v14 offset:8192
    ds_read_b128 v[76:79], v15 offset:8192
    ds_read_b128 v[80:83], v12 offset:12288
    ds_read_b128 v[84:87], v13 offset:12288
    ds_read_b128 v[88:91], v14 offset:12288
    ds_read_b128 v[92:95], v15 offset:12288
    v_readfirstlane_b32 s61, v115
    s_nop 0
    s_cmp_lt_u32 s61, 744
    s_cselect_b32 s63, 1, 0
    s_nop 1
    s_cbranch_scc0 L_noissue1
    s_lshl_b32 s61, s61, 1
    s_add_u32 s61, s61, s65
    s_lshl_b32 s61, s61, 13
    s_add_u32 s61, s61, s67
    s_and_b32 s61, s61, 0xffffff
    s_mov_b32 s10, s61
    s_add_u32 m0, s60, 0
    s_nop 0
    buffer_load_dwordx4 v8, s[40:43], s10 offen offset:0 nt lds
    buffer_load_dwordx4 v9, s[40:43], s10 offen offset:1024 nt lds
    buffer_load_dwordx4 v10, s[40:43], s10 offen offset:2048 nt lds
    buffer_load_dwordx4 v11, s[40:43], s10 offen offset:3072 nt lds
    s_add_u32 s10, s10, 4096
    s_add_u32 m0, s60, 4096
    s_nop 0
    buffer_load_dwordx4 v8, s[40:43], s10 offen offset:0 nt lds
    buffer_load_dwordx4 v9, s[40:43], s10 offen offset:1024 nt lds
    buffer_load_dwordx4 v10, s[40:43], s10 offen offset:2048 nt lds
    buffer_load_dwordx4 v11, s[40:43], s10 offen offset:3072 nt lds
L_noissue1:
    s_waitcnt lgkmcnt(7)
    v_mfma_f32_16x16x32_bf16 v[96:99], v[64:67], v[16:19], 0
    s_waitcnt lgkmcnt(6)
    v_mfma_f32_16x16x32_bf16 v[96:99], v[68:71], v[20:23], v[96:99]
    s_waitcnt lgkmcnt(5)
    v_mfma_f32_16x16x32_bf16 v[96:99], v[72:75], v[24:27], v[96:99]
    s_waitcnt lgkmcnt(4)
    v_mfma_f32_16x16x32_bf16 v[96:99], v[76:79], v[28:31], v[96:99]
    s_waitcnt lgkmcnt(3)
    v_mfma_f32_16x16x32_bf16 v[100:103], v[80:83], v[16:19], 0
    s_waitcnt lgkmcnt(2)
    v_mfma_f32_16x16x32_bf16 v[100:103], v[84:87], v[20:23], v[100:103]
    s_waitcnt lgkmcnt(1)
    v_mfma_f32_16x16x32_bf16 v[100:103], v[88:91], v[24:27], v[100:103]
    s_waitcnt lgkmcnt(0)
    v_mfma_f32_16x16x32_bf16 v[100:103], v[92:95], v[28:31], v[100:103]
    v_cvt_pk_bf16_f32 v110, v96, v97
    v_lshlrev_b32 v111, 16, v110
    v_and_b32 v112, 0xffff0000, v110
    v_mul_f32 v111, s11, v111
    v_mul_f32 v112, s11, v112
    v_cvt_pk_bf16_f32 v110, v111, v112
    v_lshlrev_b32 v116, 16, v110
    v_and_b32 v117, 0xffff0000, v110
    v_cvt_pk_bf16_f32 v110, v98, v99
    v_lshlrev_b32 v111, 16, v110
    v_and_b32 v112, 0xffff0000, v110
    v_mul_f32 v111, s11, v111
    v_mul_f32 v112, s11, v112
    v_cvt_pk_bf16_f32 v110, v111, v112
    v_lshlrev_b32 v118, 16, v110
    v_and_b32 v119, 0xffff0000, v110
    v_cvt_pk_bf16_f32 v110, v100, v101
    v_lshlrev_b32 v111, 16, v110
    v_and_b32 v112, 0xffff0000, v110
    v_mul_f32 v111, s11, v111
    v_mul_f32 v112, s11, v112
    v_cvt_pk_bf16_f32 v110, v111, v112
    v_lshlrev_b32 v120, 16, v110
    v_and_b32 v121, 0xffff0000, v110
    v_cvt_pk_bf16_f32 v110, v102, v103
    v_lshlrev_b32 v111, 16, v110
    v_and_b32 v112, 0xffff0000, v110
    v_mul_f32 v111, s11, v111
    v_mul_f32 v112, s11, v112
    v_cvt_pk_bf16_f32 v110, v111, v112
    v_lshlrev_b32 v122, 16, v110
    v_and_b32 v123, 0xffff0000, v110
    v_max3_f32 v111, v116, v117, v118
    v_max3_f32 v112, v119, v120, v121
    v_max3_f32 v111, v111, v122, v123
    v_max3_f32 v111, v111, v112, v108
    v_mov_b32 v110, v111
    s_nop 1
    v_permlane16_swap_b32 v110, v111
    v_max_f32 v111, v110, v111
    v_mov_b32 v110, v111
    s_nop 1
    v_permlane32_swap_b32 v110, v111
    v_max_f32 v111, v110, v111
    v_sub_f32 v112, v108, v111
    v_mul_f32 v113, s12, v111
    v_mul_f32 v112, s12, v112
    v_mov_b32 v108, v111
    v_exp_f32 v112, v112
    v_fma_f32 v116, v116, s12, -v113
    v_fma_f32 v117, v117, s12, -v113
    v_fma_f32 v118, v118, s12, -v113
    v_fma_f32 v119, v119, s12, -v113
    v_fma_f32 v120, v120, s12, -v113
    v_fma_f32 v121, v121, s12, -v113
    v_fma_f32 v122, v122, s12, -v113
    v_fma_f32 v123, v123, s12, -v113
    v_exp_f32 v116, v116
    v_exp_f32 v117, v117
    v_exp_f32 v118, v118
    v_exp_f32 v119, v119
    v_exp_f32 v120, v120
    v_exp_f32 v121, v121
    v_exp_f32 v122, v122
    v_exp_f32 v123, v123
    v_mul_f32 v109, v109, v112
    v_mul_f32 v32, v112, v32
    v_mul_f32 v33, v112, v33
    v_mul_f32 v34, v112, v34
    v_mul_f32 v35, v112, v35
    v_mul_f32 v36, v112, v36
    v_mul_f32 v37, v112, v37
    v_mul_f32 v38, v112, v38
    v_mul_f32 v39, v112, v39
    v_mul_f32 v40, v112, v40
    v_mul_f32 v41, v112, v41
    v_mul_f32 v42, v112, v42
    v_mul_f32 v43, v112, v43
    v_mul_f32 v44, v112, v44
    v_mul_f32 v45, v112, v45
    v_mul_f32 v46, v112, v46
    v_mul_f32 v47, v112, v47
    v_mul_f32 v48, v112, v48
    v_mul_f32 v49, v112, v49
    v_mul_f32 v50, v112, v50
    v_mul_f32 v51, v112, v51
    v_mul_f32 v52, v112, v52
    v_mul_f32 v53, v112, v53
    v_mul_f32 v54, v112, v54
    v_mul_f32 v55, v112, v55
    v_mul_f32 v56, v112, v56
    v_mul_f32 v57, v112, v57
    v_mul_f32 v58, v112, v58
    v_mul_f32 v59, v112, v59
    v_mul_f32 v60, v112, v60
    v_mul_f32 v61, v112, v61
    v_mul_f32 v62, v112, v62
    v_mul_f32 v63, v112, v63
    v_cvt_pk_bf16_f32 v104, v116, v117
    v_cvt_pk_bf16_f32 v105, v118, v119
    v_cvt_pk_bf16_f32 v106, v120, v121
    v_cvt_pk_bf16_f32 v107, v122, v123
    v_add_f32 v109, v109, v116
    v_add_f32 v109, v109, v117
    v_add_f32 v109, v109, v118
    v_add_f32 v109, v109, v119
    v_add_f32 v109, v109, v120
    v_add_f32 v109, v109, v121
    v_add_f32 v109, v109, v122
    v_add_f32 v109, v109, v123
    s_cmp_eq_u32 s63, 1
    s_nop 0
    s_cbranch_scc1 L_norm1
    s_waitcnt vmcnt(0)
    s_branch L_pv1
L_norm1:
    s_waitcnt vmcnt(8)
    v_mov_b32 v115, 1
    s_mov_b64 exec, 1
    buffer_atomic_add v115, v4, s[52:55], s62 offen sc0
    s_mov_b64 exec, -1
    s_mov_b32 s10, s61
    buffer_load_dwordx4 v[124:127], v2, s[44:47], s10 offen offset:0 nt
    buffer_load_dwordx4 v[128:131], v2, s[44:47], s10 offen offset:1024 nt
    buffer_load_dwordx4 v[132:135], v2, s[44:47], s10 offen offset:2048 nt
    buffer_load_dwordx4 v[136:139], v2, s[44:47], s10 offen offset:3072 nt
    s_add_u32 s10, s10, 4096
    buffer_load_dwordx4 v[140:143], v2, s[44:47], s10 offen offset:0 nt
    buffer_load_dwordx4 v[144:147], v2, s[44:47], s10 offen offset:1024 nt
    buffer_load_dwordx4 v[148:151], v2, s[44:47], s10 offen offset:2048 nt
    buffer_load_dwordx4 v[152:155], v2, s[44:47], s10 offen offset:3072 nt
L_pv1:
    v_perm_b32 v80, v160, v156, s13
    v_perm_b32 v84, v160, v156, s14
    v_perm_b32 v81, v168, v164, s13
    v_perm_b32 v85, v168, v164, s14
    v_perm_b32 v82, v176, v172, s13
    v_perm_b32 v86, v176, v172, s14
    v_perm_b32 v83, v184, v180, s13
    v_perm_b32 v87, v184, v180, s14
    s_nop 0
    v_mfma_f32_16x16x32_bf16 v[32:35], v[80:83], v[104:107], v[32:35]
    v_mfma_f32_16x16x32_bf16 v[36:39], v[84:87], v[104:107], v[36:39]
    v_perm_b32 v88, v161, v157, s13
    v_perm_b32 v92, v161, v157, s14
    v_perm_b32 v89, v169, v165, s13
    v_perm_b32 v93, v169, v165, s14
    v_perm_b32 v90, v177, v173, s13
    v_perm_b32 v94, v177, v173, s14
    v_perm_b32 v91, v185, v181, s13
    v_perm_b32 v95, v185, v181, s14
    s_nop 0
    v_mfma_f32_16x16x32_bf16 v[40:43], v[88:91], v[104:107], v[40:43]
    v_mfma_f32_16x16x32_bf16 v[44:47], v[92:95], v[104:107], v[44:47]
    v_perm_b32 v80, v162, v158, s13
    v_perm_b32 v84, v162, v158, s14
    v_perm_b32 v81, v170, v166, s13
    v_perm_b32 v85, v170, v166, s14
    v_perm_b32 v82, v178, v174, s13
    v_perm_b32 v86, v178, v174, s14
    v_perm_b32 v83, v186, v182, s13
    v_perm_b32 v87, v186, v182, s14
    s_nop 0
    v_mfma_f32_16x16x32_bf16 v[48:51], v[80:83], v[104:107], v[48:51]
    v_mfma_f32_16x16x32_bf16 v[52:55], v[84:87], v[104:107], v[52:55]
    v_perm_b32 v88, v163, v159, s13
    v_perm_b32 v92, v163, v159, s14
    v_perm_b32 v89, v171, v167, s13
    v_perm_b32 v93, v171, v167, s14
    v_perm_b32 v90, v179, v175, s13
    v_perm_b32 v94, v179, v175, s14
    v_perm_b32 v91, v187, v183, s13
    v_perm_b32 v95, v187, v183, s14
    s_nop 0
    v_mfma_f32_16x16x32_bf16 v[56:59], v[88:91], v[104:107], v[56:59]
    v_mfma_f32_16x16x32_bf16 v[60:63], v[92:95], v[104:107], v[60:63]
    s_cmp_eq_u32 s63, 0
    s_nop 6
    s_cbranch_scc1 L_loop_done
    s_sub_u32 s66, s66, 1
    s_cmp_lg_u32 s66, 0
    s_cbranch_scc1 L_loop
L_loop_done:
    v_mov_b32 v110, v109
    s_nop 1
    v_permlane16_swap_b32 v110, v109
    v_add_f32 v109, v110, v109
    v_mov_b32 v110, v109
    s_nop 1
    v_permlane32_swap_b32 v110, v109
    v_add_f32 v109, v110, v109
    v_and_b32 v5, 3, v1
    v_lshlrev_b32 v6, 9, v5
    v_lshl_add_u32 v6, v3, 3, v6
    s_lshl_b32 s10, s3, 11
    s_add_u32 s10, s10, 131072
    v_add_u32 v6, s10, v6
    v_mov_b32 v64, v32
    v_mov_b32 v65, v36
    v_mov_b32 v66, v40
    v_mov_b32 v67, v44
    v_mov_b32 v68, v48
    v_mov_b32 v69, v52
    v_mov_b32 v70, v56
    v_mov_b32 v71, v60
    v_mov_b32 v72, v33
    v_mov_b32 v73, v37
    v_mov_b32 v74, v41
    v_mov_b32 v75, v45
    v_mov_b32 v76, v49
    v_mov_b32 v77, v53
    v_mov_b32 v78, v57
    v_mov_b32 v79, v61
    v_mov_b32 v80, v34
    v_mov_b32 v81, v38
    v_mov_b32 v82, v42
    v_mov_b32 v83, v46
    v_mov_b32 v84, v50
    v_mov_b32 v85, v54
    v_mov_b32 v86, v58
    v_mov_b32 v87, v62
    v_mov_b32 v88, v35
    v_mov_b32 v89, v39
    v_mov_b32 v90, v43
    v_mov_b32 v91, v47
    v_mov_b32 v92, v51
    v_mov_b32 v93, v55
    v_mov_b32 v94, v59
    v_mov_b32 v95, v63
    ds_write_b128 v6, v[64:67] offset:0
    ds_write_b128 v6, v[68:71] offset:16
    ds_write_b128 v6, v[72:75] offset:32
    ds_write_b128 v6, v[76:79] offset:48
    ds_write_b128 v6, v[80:83] offset:64
    ds_write_b128 v6, v[84:87] offset:80
    ds_write_b128 v6, v[88:91] offset:96
    ds_write_b128 v6, v[92:95] offset:112
    v_lshlrev_b32 v5, 3, v5
    s_lshl_b32 s10, s3, 5
    s_add_u32 s10, s10, 147456
    v_add_u32 v5, s10, v5
    ds_write_b64 v5, v[108:109]
    s_cmp_eq_u32 s59, 0
    s_cbranch_scc1 L_nofc
    s_cmp_lg_u32 s3, 7
    s_cbranch_scc1 L_nofc
    v_lshlrev_b32 v6, 2, v1
    s_mov_b32 s57, 20000
    s_mov_b32 s58, 0x01010101
L_fc_1:
    buffer_load_dword v7, v6, s[48:51], 0 offen sc1
    s_waitcnt vmcnt(0)
    v_cmp_ne_u32 vcc, s58, v7
    s_nop 0
    s_cmp_eq_u64 vcc, 0
    s_nop 2
    s_cbranch_scc1 L_fc_1_d
    s_sub_u32 s57, s57, 1
    s_cmp_eq_u32 s57, 0
    s_cbranch_scc1 L_fc_1_d
    s_sleep 64
    s_branch L_fc_1
L_fc_1_d:
L_nofc:
    s_waitcnt vmcnt(0) lgkmcnt(0)
    s_barrier
    s_cmp_ge_u32 s3, 2
    s_cbranch_scc1 L_pub_done
    v_lshrrev_b32 v4, 5, v0
    v_lshlrev_b32 v5, 3, v4
    v_add_u32 v5, 147456, v5
    v_lshlrev_b32 v6, 4, v0
    v_add_u32 v6, 131072, v6
    ds_read_b64 v[8:9], v5 offset:0
    ds_read_b64 v[10:11], v5 offset:32
    ds_read_b64 v[12:13], v5 offset:64
    ds_read_b64 v[14:15], v5 offset:96
    ds_read_b64 v[16:17], v5 offset:128
    ds_read_b64 v[18:19], v5 offset:160
    ds_read_b64 v[20:21], v5 offset:192
    ds_read_b64 v[22:23], v5 offset:224
    ds_read_b128 v[24:27], v6 offset:0
    ds_read_b128 v[28:31], v6 offset:2048
    ds_read_b128 v[32:35], v6 offset:4096
    ds_read_b128 v[36:39], v6 offset:6144
    ds_read_b128 v[40:43], v6 offset:8192
    ds_read_b128 v[44:47], v6 offset:10240
    ds_read_b128 v[48:51], v6 offset:12288
    s_waitcnt lgkmcnt(7)
    ds_read_b128 v[52:55], v6 offset:14336
    v_max3_f32 v56, v8, v10, v12
    v_max3_f32 v56, v56, v14, v16
    v_max3_f32 v56, v56, v18, v20
    v_max_f32 v56, v56, v22
    v_sub_f32 v8, v8, v56
    v_sub_f32 v10, v10, v56
    v_sub_f32 v12, v12, v56
    v_sub_f32 v14, v14, v56
    v_sub_f32 v16, v16, v56
    v_sub_f32 v18, v18, v56
    v_sub_f32 v20, v20, v56
    v_sub_f32 v22, v22, v56
    v_mul_f32 v8, s12, v8
    v_mul_f32 v10, s12, v10
    v_mul_f32 v12, s12, v12
    v_mul_f32 v14, s12, v14
    v_mul_f32 v16, s12, v16
    v_mul_f32 v18, s12, v18
    v_mul_f32 v20, s12, v20
    v_mul_f32 v22, s12, v22
    v_exp_f32 v8, v8
    v_exp_f32 v10, v10
    v_exp_f32 v12, v12
    v_exp_f32 v14, v14
    v_exp_f32 v16, v16
    v_exp_f32 v18, v18
    v_exp_f32 v20, v20
    v_exp_f32 v22, v22
    s_lshl_b32 s10, s4, 7
    s_add_u32 s10, s10, s5
    v_lshlrev_b32 v6, 5, v4
    v_add_u32 v6, s10, v6
    v_lshlrev_b32 v7, 9, v6
    v_and_b32 v5, 31, v0
    v_lshl_add_u32 v7, v5, 4, v7
    v_lshlrev_b32 v6, 3, v6
    s_mov_b32 s10, 147456
    s_mov_b32 s11, 671744
    s_waitcnt lgkmcnt(0)
    v_mul_f32 v60, v8, v24
    v_mul_f32 v61, v8, v25
    v_mul_f32 v62, v8, v26
    v_mul_f32 v63, v8, v27
    v_fmac_f32 v60, v10, v28
    v_fmac_f32 v61, v10, v29
    v_fmac_f32 v62, v10, v30
    v_fmac_f32 v63, v10, v31
    v_fmac_f32 v60, v12, v32
    v_fmac_f32 v61, v12, v33
    v_fmac_f32 v62, v12, v34
    v_fmac_f32 v63, v12, v35
    v_fmac_f32 v60, v14, v36
    v_fmac_f32 v61, v14, v37
    v_fmac_f32 v62, v14, v38
    v_fmac_f32 v63, v14, v39
    v_fmac_f32 v60, v16, v40
    v_fmac_f32 v61, v16, v41
    v_fmac_f32 v62, v16, v42
    v_fmac_f32 v63, v16, v43
    v_fmac_f32 v60, v18, v44
    v_fmac_f32 v61, v18, v45
    v_fmac_f32 v62, v18, v46
    v_fmac_f32 v63, v18, v47
    v_fmac_f32 v60, v20, v48
    v_fmac_f32 v61, v20, v49
    v_fmac_f32 v62, v20, v50
    v_fmac_f32 v63, v20, v51
    v_fmac_f32 v60, v22, v52
    v_fmac_f32 v61, v22, v53
    v_fmac_f32 v62, v22, v54
    v_fmac_f32 v63, v22, v55
    buffer_store_dwordx4 v[60:63], v7, s[52:55], s10 offen sc1
    v_mul_f32 v57, v8, v9
    v_fmac_f32 v57, v10, v11
    v_fmac_f32 v57, v12, v13
    v_fmac_f32 v57, v14, v15
    v_fmac_f32 v57, v16, v17
    v_fmac_f32 v57, v18, v19
    v_fmac_f32 v57, v20, v21
    v_fmac_f32 v57, v22, v23
    s_mov_b32 exec_lo, 1
    s_mov_b32 exec_hi, 1
    buffer_store_dwordx2 v[56:57], v6, s[52:55], s11 offen sc1
    s_mov_b64 exec, -1
L_pub_done:
    s_cmp_eq_u32 s59, 0
    s_cbranch_scc1 L_done
    s_cmp_eq_u32 s59, 2
    s_cbranch_scc1 L_stC
    s_cmp_eq_u32 s59, 3
    s_cbranch_scc1 L_stD
    v_lshrrev_b32 v4, 5, v1
    v_lshlrev_b32 v4, 9, v4
    v_and_b32 v5, 31, v1
    v_lshl_add_u32 v4, v5, 4, v4
    s_lshl_b32 s10, s9, 14
    s_lshl_b32 s11, s3, 11
    s_add_u32 s10, s10, s11
    s_add_u32 s10, s10, 147456
    v_lshlrev_b32 v6, 3, v5
    s_lshl_b32 s11, s9, 8
    s_add_u32 s11, s11, 671744
    v_lshrrev_b32 v72, 5, v1
    s_lshl_b32 s13, s3, 2
    v_add_u32 v72, s13, v72
    v_lshlrev_b32 v72, 2, v72
    s_lshl_b32 s13, s3, 9
    v_lshlrev_b32 v73, 4, v5
    v_add_u32 v73, s13, v73
    v_lshlrev_b32 v74, 3, v1
    s_lshl_b32 s13, s3, 8
    s_add_u32 s13, s13, 4096
    v_lshlrev_b32 v75, 2, v1
    v_add_u32 v75, s13, v75
    v_add_u32 v76, s13, v3
    s_lshl_b32 s13, s3, 8
    s_lshl_b32 s14, s9, 11
    s_add_u32 s14, s14, s13
    s_add_u32 s14, s14, 73728
    v_and_b32 v7, 15, v1
    v_lshl_add_u32 v77, v7, 6, v3
    v_cmp_eq_u32 s[78:79], 1, v7
    v_cmp_eq_u32 s[80:81], 2, v7
    v_cmp_eq_u32 s[82:83], 3, v7
    s_mov_b64 s[68:69], -1
    s_mov_b64 s[70:71], -1
    s_mov_b64 s[72:73], -1
    s_mov_b32 s57, 20000
    s_nop 0
L_mp_2:
    s_mov_b64 exec, s[68:69]
    s_cbranch_execz L_mp_2_s0
    buffer_load_dwordx4 v[8:11], v4, s[52:55], s10 offen sc1
L_mp_2_s0:
    s_mov_b64 exec, s[70:71]
    s_cbranch_execz L_mp_2_s1
    buffer_load_dwordx4 v[12:15], v4, s[52:55], s10 offen offset:1024 sc1
L_mp_2_s1:
    s_mov_b64 exec, s[72:73]
    s_cbranch_execz L_mp_2_s2
    buffer_load_dwordx2 v[16:17], v6, s[52:55], s11 offen sc1
L_mp_2_s2:
    s_mov_b64 exec, -1
    s_sub_u32 s57, s57, 1
    s_cmp_eq_u32 s57, 0
    s_waitcnt vmcnt(0)
    s_cbranch_scc1 L_mp_2_done
    v_max3_u32 v78, v8, v9, v10
    v_max_u32 v78, v78, v11
    v_cmp_eq_u32 s[68:69], -1, v78
    v_max3_u32 v78, v12, v13, v14
    v_max_u32 v78, v78, v15
    v_cmp_eq_u32 s[70:71], -1, v78
    v_max_u32 v78, v16, v17
    v_cmp_eq_u32 s[72:73], -1, v78
    s_mov_b64 vcc, s[68:69]
    s_or_b64 vcc, vcc, s[70:71]
    s_or_b64 vcc, vcc, s[72:73]
    s_cmp_lg_u64 vcc, 0
    s_cbranch_scc1 L_mp_2
L_mp_2_done:
    v_mov_b32 v18, v16
    s_nop 1
    v_max_f32_dpp v18, v18, v18 row_ror:8 row_mask:0xf bank_mask:0xf
    s_nop 1
    v_max_f32_dpp v18, v18, v18 row_ror:4 row_mask:0xf bank_mask:0xf
    s_nop 1
    v_max_f32_dpp v18, v18, v18 row_ror:2 row_mask:0xf bank_mask:0xf
    s_nop 1
    v_max_f32_dpp v18, v18, v18 row_ror:1 row_mask:0xf bank_mask:0xf
    v_mov_b32 v19, v18
    s_nop 1
    v_permlane16_swap_b32 v19, v18
    v_max_f32 v18, v19, v18
    v_sub_f32 v16, v16, v18
    v_mul_f32 v16, s12, v16
    v_exp_f32 v16, v16
    s_nop 0
    v_mul_f32 v17, v16, v17
    ds_bpermute_b32 v20, v72, v16
    ds_bpermute_b32 v21, v72, v16 offset:8
    v_add_f32_dpp v17, v17, v17 row_ror:8 row_mask:0xf bank_mask:0xf
    s_nop 1
    v_add_f32_dpp v17, v17, v17 row_ror:4 row_mask:0xf bank_mask:0xf
    s_nop 1
    v_add_f32_dpp v17, v17, v17 row_ror:2 row_mask:0xf bank_mask:0xf
    s_nop 1
    v_add_f32_dpp v17, v17, v17 row_ror:1 row_mask:0xf bank_mask:0xf
    v_mov_b32 v19, v17
    s_nop 1
    v_permlane16_swap_b32 v19, v17
    v_add_f32 v17, v19, v17
    v_rcp_f32 v19, v17
    s_waitcnt lgkmcnt(0)
    v_mul_f32 v8, v20, v8
    v_mul_f32 v9, v20, v9
    v_mul_f32 v10, v20, v10
    v_mul_f32 v11, v20, v11
    v_fmac_f32 v8, v21, v12
    v_fmac_f32 v9, v21, v13
    v_fmac_f32 v10, v21, v14
    v_fmac_f32 v11, v21, v15
    v_mov_b32 v24, v8
    v_mov_b32 v25, v9
    v_mov_b32 v26, v10
    v_mov_b32 v27, v11
    v_permlane32_swap_b32 v24, v8
    v_permlane32_swap_b32 v25, v9
    v_permlane32_swap_b32 v26, v10
    v_permlane32_swap_b32 v27, v11
    v_add_f32 v8, v24, v8
    v_add_f32 v9, v25, v9
    v_add_f32 v10, v26, v10
    v_add_f32 v11, v27, v11
    ds_write_b128 v73, v[8:11]
    s_waitcnt lgkmcnt(0)
    s_barrier
    ds_read_b64 v[24:25], v74 offset:0
    ds_read_b64 v[26:27], v74 offset:512
    ds_read_b64 v[28:29], v74 offset:1024
    ds_read_b64 v[30:31], v74 offset:1536
    ds_read_b64 v[32:33], v74 offset:2048
    ds_read_b64 v[34:35], v74 offset:2560
    ds_read_b64 v[36:37], v74 offset:3072
    ds_read_b64 v[38:39], v74 offset:3584
    s_waitcnt lgkmcnt(0)
    v_add_f32 v24, v24, v26
    v_add_f32 v25, v25, v27
    v_add_f32 v24, v24, v28
    v_add_f32 v25, v25, v29
    v_add_f32 v24, v24, v30
    v_add_f32 v25, v25, v31
    v_add_f32 v24, v24, v32
    v_add_f32 v25, v25, v33
    v_add_f32 v24, v24, v34
    v_add_f32 v25, v25, v35
    v_add_f32 v24, v24, v36
    v_add_f32 v25, v25, v37
    v_add_f32 v24, v24, v38
    v_add_f32 v25, v25, v39
    v_mul_f32 v26, v24, v19
    v_mul_f32 v27, v25, v19
    v_fma_f32 v28, -v26, v17, v24
    v_fma_f32 v29, -v27, v17, v25
    v_fma_f32 v24, v28, v19, v26
    v_fma_f32 v25, v29, v19, v27
    v_cvt_pk_bf16_f32 v24, v24, v25
    ds_write_b32 v75, v24
    s_waitcnt lgkmcnt(0)
    ds_read_b128 v[32:35], v76 offset:0
    ds_read_b128 v[36:39], v76 offset:64
    ds_read_b128 v[40:43], v76 offset:128
    ds_read_b128 v[44:47], v76 offset:192
    s_waitcnt lgkmcnt(3)
    v_mfma_f32_16x16x32_bf16 v[48:51], v[188:191], v[32:35], 0
    v_mfma_f32_16x16x32_bf16 v[52:55], v[204:207], v[32:35], 0
    v_mfma_f32_16x16x32_bf16 v[56:59], v[220:223], v[32:35], 0
    v_mfma_f32_16x16x32_bf16 v[60:63], v[236:239], v[32:35], 0
    s_waitcnt lgkmcnt(2)
    v_mfma_f32_16x16x32_bf16 v[48:51], v[192:195], v[36:39], v[48:51]
    v_mfma_f32_16x16x32_bf16 v[52:55], v[208:211], v[36:39], v[52:55]
    v_mfma_f32_16x16x32_bf16 v[56:59], v[224:227], v[36:39], v[56:59]
    v_mfma_f32_16x16x32_bf16 v[60:63], v[240:243], v[36:39], v[60:63]
    s_waitcnt lgkmcnt(1)
    v_mfma_f32_16x16x32_bf16 v[48:51], v[196:199], v[40:43], v[48:51]
    v_mfma_f32_16x16x32_bf16 v[52:55], v[212:215], v[40:43], v[52:55]
    v_mfma_f32_16x16x32_bf16 v[56:59], v[228:231], v[40:43], v[56:59]
    v_mfma_f32_16x16x32_bf16 v[60:63], v[244:247], v[40:43], v[60:63]
    s_waitcnt lgkmcnt(0)
    v_mfma_f32_16x16x32_bf16 v[48:51], v[200:203], v[44:47], v[48:51]
    v_mfma_f32_16x16x32_bf16 v[52:55], v[216:219], v[44:47], v[52:55]
    v_mfma_f32_16x16x32_bf16 v[56:59], v[232:235], v[44:47], v[56:59]
    v_mfma_f32_16x16x32_bf16 v[60:63], v[248:251], v[44:47], v[60:63]
    s_nop 5
    v_cndmask_b32 v48, v48, v52, s[78:79]
    v_cndmask_b32 v49, v49, v53, s[78:79]
    v_cndmask_b32 v50, v50, v54, s[78:79]
    v_cndmask_b32 v51, v51, v55, s[78:79]
    v_cndmask_b32 v48, v48, v56, s[80:81]
    v_cndmask_b32 v49, v49, v57, s[80:81]
    v_cndmask_b32 v50, v50, v58, s[80:81]
    v_cndmask_b32 v51, v51, v59, s[80:81]
    v_cndmask_b32 v48, v48, v60, s[82:83]
    v_cndmask_b32 v49, v49, v61, s[82:83]
    v_cndmask_b32 v50, v50, v62, s[82:83]
    v_cndmask_b32 v51, v51, v63, s[82:83]
    s_mov_b32 exec_lo, 0x000f000f
    s_mov_b32 exec_hi, 0x000f000f
    buffer_store_dwordx4 v[48:51], v77, s[52:55], s14 offen sc1
    s_mov_b64 exec, -1
    s_nop 0
    s_branch L_done
L_stC:
    s_mov_b32 s72, s16
    s_and_b32 s73, s17, 0xffff
    s_mov_b32 s74, 1024
    s_mov_b32 s75, 0x20000
    v_and_b32 v5, 15, v1
    v_lshlrev_b32 v6, 3, v5
    s_lshl_b32 s10, s3, 7
    buffer_load_dwordx2 v[64:65], v6, s[72:75], s10 offen
    v_lshlrev_b32 v6, 7, v3
    v_lshl_add_u32 v6, v5, 4, v6
    s_lshl_b32 s10, s3, 8
    s_add_u32 s76, s10, 73728
    s_add_u32 s77, s10, 81920
    s_add_u32 s78, s10, 90112
    s_add_u32 s79, s10, 98304
    s_add_u32 s80, s10, 106496
    s_add_u32 s81, s10, 114688
    s_add_u32 s82, s10, 122880
    s_add_u32 s83, s10, 131072
    s_lshl_b32 s13, s3, 3
    v_mov_b32 v70, s13
    v_mov_b32 v71, 0
    s_lshl_b32 s13, s3, 7
    s_add_u32 s13, s13, 1024
    v_lshlrev_b32 v72, 3, v5
    v_add_u32 v72, s13, v72
    v_add_u32 v73, s13, v3
    s_lshl_b32 s13, s3, 9
    s_add_u32 s13, s13, 4096
    v_add_u32 v74, s13, v3
    v_lshlrev_b32 v75, 2, v1
    v_add_u32 v75, 4096, v75
    v_add_u32 v80, 1024, v75
    v_add_u32 v81, 2048, v75
    v_add_u32 v82, 3072, v75
    v_lshlrev_b32 v76, 1, v1
    s_lshl_b32 s14, s9, 7
    s_add_u32 s14, s14, 139264
    v_lshlrev_b32 v77, 4, v5
    s_lshl_b32 s11, s3, 8
    s_add_u32 s11, s11, 143360
    v_mov_b32 v16, 0x3f803f80
    v_mov_b32 v17, 0x3f803f80
    v_mov_b32 v18, 0x3f803f80
    v_mov_b32 v19, 0x3f803f80
    s_nop 1
    v_mfma_f32_16x16x32_bf16 v[32:35], v[188:191], v[16:19], 0
    v_mfma_f32_16x16x32_bf16 v[36:39], v[204:207], v[16:19], 0
    v_mfma_f32_16x16x32_bf16 v[40:43], v[220:223], v[16:19], 0
    v_mfma_f32_16x16x32_bf16 v[44:47], v[236:239], v[16:19], 0
    v_mfma_f32_16x16x32_bf16 v[48:51], v[196:199], v[16:19], 0
    v_mfma_f32_16x16x32_bf16 v[52:55], v[212:215], v[16:19], 0
    v_mfma_f32_16x16x32_bf16 v[56:59], v[228:231], v[16:19], 0
    v_mfma_f32_16x16x32_bf16 v[60:63], v[244:247], v[16:19], 0
    v_mfma_f32_16x16x32_bf16 v[32:35], v[192:195], v[16:19], v[32:35]
    v_mfma_f32_16x16x32_bf16 v[36:39], v[208:211], v[16:19], v[36:39]
    v_mfma_f32_16x16x32_bf16 v[40:43], v[224:227], v[16:19], v[40:43]
    v_mfma_f32_16x16x32_bf16 v[44:47], v[240:243], v[16:19], v[44:47]
    v_mfma_f32_16x16x32_bf16 v[48:51], v[200:203], v[16:19], v[48:51]
    v_mfma_f32_16x16x32_bf16 v[52:55], v[216:219], v[16:19], v[52:55]
    v_mfma_f32_16x16x32_bf16 v[56:59], v[232:235], v[16:19], v[56:59]
    v_mfma_f32_16x16x32_bf16 v[60:63], v[248:251], v[16:19], v[60:63]
    s_mov_b32 exec_lo, 0x00010001
    s_mov_b32 exec_hi, 0x00010001
    ds_write_b128 v74, v[32:35] offset:0
    ds_write_b128 v74, v[36:39] offset:64
    ds_write_b128 v74, v[40:43] offset:128
    ds_write_b128 v74, v[44:47] offset:192
    ds_write_b128 v74, v[48:51] offset:256
    ds_write_b128 v74, v[52:55] offset:320
    ds_write_b128 v74, v[56:59] offset:384
    ds_write_b128 v74, v[60:63] offset:448
    s_mov_b64 exec, -1
    s_waitcnt lgkmcnt(0)
    s_barrier
    ds_read2_b32 v[84:85], v75 offset0:0 offset1:64
    ds_read2_b32 v[86:87], v75 offset0:128 offset1:192
    ds_read2_b32 v[88:89], v80 offset0:0 offset1:64
    ds_read2_b32 v[90:91], v80 offset0:128 offset1:192
    ds_read2_b32 v[92:93], v81 offset0:0 offset1:64
    ds_read2_b32 v[94:95], v81 offset0:128 offset1:192
    ds_read2_b32 v[96:97], v82 offset0:0 offset1:64
    ds_read2_b32 v[98:99], v82 offset0:128 offset1:192
    s_waitcnt lgkmcnt(0)
    v_add_f32 v84, v84, v86
    v_add_f32 v85, v85, v87
    v_add_f32 v88, v88, v90
    v_add_f32 v89, v89, v91
    v_add_f32 v92, v92, v94
    v_add_f32 v93, v93, v95
    v_add_f32 v96, v96, v98
    v_add_f32 v97, v97, v99
    v_add_f32 v84, v84, v88
    v_add_f32 v85, v85, v89
    v_add_f32 v92, v92, v96
    v_add_f32 v93, v93, v97
    v_add_f32 v84, v84, v92
    v_add_f32 v85, v85, v93
    s_waitcnt vmcnt(0)
    v_lshlrev_b32 v66, 16, v64
    v_and_b32 v67, 0xffff0000, v64
    v_lshlrev_b32 v68, 16, v65
    v_and_b32 v69, 0xffff0000, v65
    s_barrier
    s_mov_b32 s57, 20000
L_can_3:
    buffer_load_dword v16, v6, s[52:55], s76 offen sc1
    s_sub_u32 s57, s57, 1
    s_cmp_eq_u32 s57, 0
    s_waitcnt vmcnt(0)
    s_cbranch_scc1 L_can_3_done
    v_cmp_ne_u32 vcc, -1, v16
    s_nop 0
    s_cbranch_vccnz L_can_3_done
    s_sleep 6
    s_branch L_can_3
    s_nop 0
L_can_3_done:
    s_mov_b64 s[16:17], -1
    s_mov_b64 s[18:19], -1
    s_mov_b64 s[20:21], -1
    s_mov_b64 s[22:23], -1
    s_mov_b64 s[24:25], -1
    s_mov_b64 s[26:27], -1
    s_mov_b64 s[28:29], -1
    s_mov_b64 s[30:31], -1
    s_mov_b32 s57, 20000
L_mp_4:
    s_mov_b64 exec, s[16:17]
    s_cbranch_execz L_mp_4_s0
    buffer_load_dwordx4 v[16:19], v6, s[52:55], s76 offen sc1
L_mp_4_s0:
    s_mov_b64 exec, s[18:19]
    s_cbranch_execz L_mp_4_s1
    buffer_load_dwordx4 v[20:23], v6, s[52:55], s77 offen sc1
L_mp_4_s1:
    s_mov_b64 exec, s[20:21]
    s_cbranch_execz L_mp_4_s2
    buffer_load_dwordx4 v[24:27], v6, s[52:55], s78 offen sc1
L_mp_4_s2:
    s_mov_b64 exec, s[22:23]
    s_cbranch_execz L_mp_4_s3
    buffer_load_dwordx4 v[28:31], v6, s[52:55], s79 offen sc1
L_mp_4_s3:
    s_mov_b64 exec, s[24:25]
    s_cbranch_execz L_mp_4_s4
    buffer_load_dwordx4 v[32:35], v6, s[52:55], s80 offen sc1
L_mp_4_s4:
    s_mov_b64 exec, s[26:27]
    s_cbranch_execz L_mp_4_s5
    buffer_load_dwordx4 v[36:39], v6, s[52:55], s81 offen sc1
L_mp_4_s5:
    s_mov_b64 exec, s[28:29]
    s_cbranch_execz L_mp_4_s6
    buffer_load_dwordx4 v[40:43], v6, s[52:55], s82 offen sc1
L_mp_4_s6:
    s_mov_b64 exec, s[30:31]
    s_cbranch_execz L_mp_4_s7
    buffer_load_dwordx4 v[44:47], v6, s[52:55], s83 offen sc1
L_mp_4_s7:
    s_mov_b64 exec, -1
    s_sub_u32 s57, s57, 1
    s_cmp_eq_u32 s57, 0
    s_waitcnt vmcnt(0)
    s_cbranch_scc1 L_mp_4_done
    v_max3_u32 v78, v16, v17, v18
    v_max_u32 v78, v78, v19
    v_cmp_eq_u32 s[16:17], -1, v78
    v_max3_u32 v78, v20, v21, v22
    v_max_u32 v78, v78, v23
    v_cmp_eq_u32 s[18:19], -1, v78
    v_max3_u32 v78, v24, v25, v26
    v_max_u32 v78, v78, v27
    v_cmp_eq_u32 s[20:21], -1, v78
    v_max3_u32 v78, v28, v29, v30
    v_max_u32 v78, v78, v31
    v_cmp_eq_u32 s[22:23], -1, v78
    v_max3_u32 v78, v32, v33, v34
    v_max_u32 v78, v78, v35
    v_cmp_eq_u32 s[24:25], -1, v78
    v_max3_u32 v78, v36, v37, v38
    v_max_u32 v78, v78, v39
    v_cmp_eq_u32 s[26:27], -1, v78
    v_max3_u32 v78, v40, v41, v42
    v_max_u32 v78, v78, v43
    v_cmp_eq_u32 s[28:29], -1, v78
    v_max3_u32 v78, v44, v45, v46
    v_max_u32 v78, v78, v47
    v_cmp_eq_u32 s[30:31], -1, v78
    s_mov_b64 vcc, s[16:17]
    s_or_b64 vcc, vcc, s[18:19]
    s_or_b64 vcc, vcc, s[20:21]
    s_or_b64 vcc, vcc, s[22:23]
    s_or_b64 vcc, vcc, s[24:25]
    s_or_b64 vcc, vcc, s[26:27]
    s_or_b64 vcc, vcc, s[28:29]
    s_or_b64 vcc, vcc, s[30:31]
    s_cmp_lg_u64 vcc, 0
    s_cbranch_scc1 L_mp_4
L_mp_4_done:
    v_add_f32 v16, v16, v20
    v_add_f32 v17, v17, v21
    v_add_f32 v18, v18, v22
    v_add_f32 v19, v19, v23
    v_add_f32 v24, v24, v28
    v_add_f32 v25, v25, v29
    v_add_f32 v26, v26, v30
    v_add_f32 v27, v27, v31
    v_add_f32 v32, v32, v36
    v_add_f32 v33, v33, v37
    v_add_f32 v34, v34, v38
    v_add_f32 v35, v35, v39
    v_add_f32 v40, v40, v44
    v_add_f32 v41, v41, v45
    v_add_f32 v42, v42, v46
    v_add_f32 v43, v43, v47
    v_add_f32 v16, v16, v24
    v_add_f32 v17, v17, v25
    v_add_f32 v18, v18, v26
    v_add_f32 v19, v19, v27
    v_add_f32 v32, v32, v40
    v_add_f32 v33, v33, v41
    v_add_f32 v34, v34, v42
    v_add_f32 v35, v35, v43
    v_add_f32 v16, v16, v32
    v_add_f32 v17, v17, v33
    v_add_f32 v18, v18, v34
    v_add_f32 v19, v19, v35
    v_mov_b32 v20, v16
    v_mov_b32 v21, v17
    v_mov_b32 v22, v18
    v_mov_b32 v23, v19
    v_permlane16_swap_b32 v20, v16
    v_permlane16_swap_b32 v21, v17
    v_permlane16_swap_b32 v22, v18
    v_permlane16_swap_b32 v23, v19
    v_add_f32 v16, v20, v16
    v_add_f32 v17, v21, v17
    v_add_f32 v18, v22, v18
    v_add_f32 v19, v23, v19
    v_mov_b32 v20, v16
    v_mov_b32 v21, v17
    v_mov_b32 v22, v18
    v_mov_b32 v23, v19
    v_permlane32_swap_b32 v20, v16
    v_permlane32_swap_b32 v21, v17
    v_permlane32_swap_b32 v22, v18
    v_permlane32_swap_b32 v23, v19
    v_add_f32 v16, v20, v16
    v_add_f32 v17, v21, v17
    v_add_f32 v18, v22, v18
    v_add_f32 v19, v23, v19
    v_cvt_pk_bf16_f32 v20, v16, v17
    v_cvt_pk_bf16_f32 v21, v18, v19
    v_lshlrev_b32 v16, 16, v20
    v_and_b32 v17, 0xffff0000, v20
    v_lshlrev_b32 v18, 16, v21
    v_and_b32 v19, 0xffff0000, v21
    v_add_f32 v16, v16, v66
    v_add_f32 v17, v17, v67
    v_add_f32 v18, v18, v68
    v_add_f32 v19, v19, v69
    v_cvt_pk_bf16_f32 v20, v16, v17
    v_cvt_pk_bf16_f32 v21, v18, v19
    ds_write_b64 v72, v[20:21]
    v_lshlrev_b32 v16, 16, v20
    v_and_b32 v17, 0xffff0000, v20
    v_lshlrev_b32 v18, 16, v21
    v_and_b32 v19, 0xffff0000, v21
    v_add_f32 v8, v16, v17
    v_add_f32 v9, v18, v19
    s_waitcnt lgkmcnt(0)
    ds_read_b128 v[24:27], v73
    ds_read_b128 v[28:31], v73 offset:64
    v_add_f32 v8, v8, v9
    s_nop 1
    v_add_f32_dpp v8, v8, v8 row_ror:8 row_mask:0xf bank_mask:0xf
    s_nop 1
    v_add_f32_dpp v8, v8, v8 row_ror:4 row_mask:0xf bank_mask:0xf
    s_nop 1
    v_add_f32_dpp v8, v8, v8 row_ror:2 row_mask:0xf bank_mask:0xf
    s_nop 1
    v_add_f32_dpp v8, v8, v8 row_ror:1 row_mask:0xf bank_mask:0xf
    v_mul_f32 v10, 0x3c800000, v8
    s_waitcnt lgkmcnt(1)
    v_mfma_f32_16x16x32_bf16 v[32:35], v[188:191], v[24:27], 0
    v_mfma_f32_16x16x32_bf16 v[36:39], v[204:207], v[24:27], 0
    v_mfma_f32_16x16x32_bf16 v[40:43], v[220:223], v[24:27], 0
    v_mfma_f32_16x16x32_bf16 v[44:47], v[236:239], v[24:27], 0
    v_mfma_f32_16x16x32_bf16 v[48:51], v[196:199], v[24:27], 0
    v_mfma_f32_16x16x32_bf16 v[52:55], v[212:215], v[24:27], 0
    v_mfma_f32_16x16x32_bf16 v[56:59], v[228:231], v[24:27], 0
    v_mfma_f32_16x16x32_bf16 v[60:63], v[244:247], v[24:27], 0
    s_waitcnt lgkmcnt(0)
    v_mfma_f32_16x16x32_bf16 v[32:35], v[192:195], v[28:31], v[32:35]
    v_mfma_f32_16x16x32_bf16 v[36:39], v[208:211], v[28:31], v[36:39]
    v_mfma_f32_16x16x32_bf16 v[40:43], v[224:227], v[28:31], v[40:43]
    v_mfma_f32_16x16x32_bf16 v[44:47], v[240:243], v[28:31], v[44:47]
    v_mfma_f32_16x16x32_bf16 v[48:51], v[200:203], v[28:31], v[48:51]
    v_mfma_f32_16x16x32_bf16 v[52:55], v[216:219], v[28:31], v[52:55]
    v_mfma_f32_16x16x32_bf16 v[56:59], v[232:235], v[28:31], v[56:59]
    v_mfma_f32_16x16x32_bf16 v[60:63], v[248:251], v[28:31], v[60:63]
    v_sub_f32 v12, v16, v10
    v_sub_f32 v13, v17, v10
    v_sub_f32 v14, v18, v10
    v_sub_f32 v15, v19, v10
    v_mul_f32 v9, v12, v12
    v_fmac_f32 v9, v13, v13
    v_fmac_f32 v9, v14, v14
    v_fmac_f32 v9, v15, v15
    s_nop 1
    v_add_f32_dpp v9, v9, v9 row_ror:8 row_mask:0xf bank_mask:0xf
    s_nop 1
    v_add_f32_dpp v9, v9, v9 row_ror:4 row_mask:0xf bank_mask:0xf
    s_nop 1
    v_add_f32_dpp v9, v9, v9 row_ror:2 row_mask:0xf bank_mask:0xf
    s_nop 1
    v_add_f32_dpp v9, v9, v9 row_ror:1 row_mask:0xf bank_mask:0xf
    ds_write_b64 v70, v[8:9]
    s_mov_b32 exec_lo, 0x00010001
    s_mov_b32 exec_hi, 0x00010001
    ds_write_b128 v74, v[32:35] offset:0
    ds_write_b128 v74, v[36:39] offset:64
    ds_write_b128 v74, v[40:43] offset:128
    ds_write_b128 v74, v[44:47] offset:192
    ds_write_b128 v74, v[48:51] offset:256
    ds_write_b128 v74, v[52:55] offset:320
    ds_write_b128 v74, v[56:59] offset:384
    ds_write_b128 v74, v[60:63] offset:448
    s_mov_b64 exec, -1
    s_cmp_lg_u32 s9, 0
    s_cbranch_scc1 L_C_noh
    s_mov_b64 exec, 0xffff
    buffer_store_dwordx4 v[16:19], v77, s[52:55], s11 offen sc1
    s_mov_b64 exec, -1
    s_nop 0
L_C_noh:
    s_waitcnt lgkmcnt(0)
    s_barrier
    s_cmp_lg_u32 s3, 0
    s_cbranch_scc1 L_done
    ds_read_b128 v[32:35], v71 offset:0
    ds_read_b128 v[36:39], v71 offset:16
    ds_read_b128 v[40:43], v71 offset:32
    ds_read_b128 v[44:47], v71 offset:48
    ds_read2_b32 v[48:49], v75 offset0:0 offset1:64
    ds_read2_b32 v[50:51], v75 offset0:128 offset1:192
    ds_read2_b32 v[52:53], v80 offset0:0 offset1:64
    ds_read2_b32 v[54:55], v80 offset0:128 offset1:192
    ds_read2_b32 v[56:57], v81 offset0:0 offset1:64
    ds_read2_b32 v[58:59], v81 offset0:128 offset1:192
    ds_read2_b32 v[60:61], v82 offset0:0 offset1:64
    ds_read2_b32 v[62:63], v82 offset0:128 offset1:192
    s_mov_b32 s10, 0x3c800000
    s_waitcnt lgkmcnt(8)
    v_add_f32 v24, v32, v34
    v_add_f32 v25, v36, v38
    v_add_f32 v26, v40, v42
    v_add_f32 v27, v44, v46
    v_add_f32 v24, v24, v25
    v_add_f32 v26, v26, v27
    v_add_f32 v25, v33, v35
    v_add_f32 v24, v24, v26
    v_add_f32 v26, v37, v39
    v_mul_f32 v24, 0x3b000000, v24
    v_add_f32 v27, v41, v43
    v_add_f32 v28, v45, v47
    v_fma_f32 v32, v32, s10, -v24
    v_fma_f32 v34, v34, s10, -v24
    v_fma_f32 v36, v36, s10, -v24
    v_fma_f32 v38, v38, s10, -v24
    v_fma_f32 v40, v40, s10, -v24
    v_fma_f32 v42, v42, s10, -v24
    v_fma_f32 v44, v44, s10, -v24
    v_fma_f32 v46, v46, s10, -v24
    v_add_f32 v25, v25, v26
    v_add_f32 v27, v27, v28
    v_mul_f32 v26, v32, v32
    v_mul_f32 v28, v34, v34
    v_fmac_f32 v26, v36, v36
    v_fmac_f32 v28, v38, v38
    v_fmac_f32 v26, v40, v40
    v_fmac_f32 v28, v42, v42
    v_fmac_f32 v26, v44, v44
    v_fmac_f32 v28, v46, v46
    v_add_f32 v25, v25, v27
    v_add_f32 v26, v26, v28
    v_fmac_f32 v25, 0x42800000, v26
    v_mul_f32 v25, 0x3b000000, v25
    v_cvt_pk_bf16_f32 v26, v24, v25
    v_lshlrev_b32 v24, 16, v26
    v_and_b32 v25, 0xffff0000, v26
    v_add_f32 v25, 0x3727c5ac, v25
    v_cvt_pk_bf16_f32 v25, v25, v25
    v_lshlrev_b32 v25, 16, v25
    v_sqrt_f32 v25, v25
    s_waitcnt lgkmcnt(0)
    v_add_f32 v48, v48, v50
    v_add_f32 v49, v49, v51
    v_add_f32 v52, v52, v54
    v_add_f32 v53, v53, v55
    v_add_f32 v56, v56, v58
    v_add_f32 v57, v57, v59
    v_add_f32 v60, v60, v62
    v_add_f32 v61, v61, v63
    v_add_f32 v48, v48, v52
    v_add_f32 v49, v49, v53
    v_add_f32 v56, v56, v60
    v_add_f32 v57, v57, v61
    v_add_f32 v48, v48, v56
    v_add_f32 v49, v49, v57
    v_cvt_pk_bf16_f32 v25, v25, v25
    v_lshlrev_b32 v25, 16, v25
    v_rcp_f32 v26, v25
    v_fma_f32 v48, -v24, v84, v48
    v_fma_f32 v49, -v24, v85, v49
    v_fma_f32 v27, -v25, v26, 1.0
    v_fma_f32 v26, v27, v26, v26
    v_mul_f32 v48, v48, v26
    v_mul_f32 v49, v49, v26
    v_cvt_pk_bf16_f32 v18, v48, v49
    v_lshlrev_b32 v16, 16, v18
    v_and_b32 v17, 0xffff0000, v18
    v_mul_f32 v18, s12, v16
    v_max_f32 v18, 0xc2fc0000, v18
    v_exp_f32 v18, -v18
    s_nop 0
    v_add_f32 v18, 1.0, v18
    v_rcp_f32 v19, v18
    s_nop 0
    v_fma_f32 v18, -v18, v19, 1.0
    v_fma_f32 v19, v18, v19, v19
    v_cvt_pk_bf16_f32 v19, v19, v19
    v_lshlrev_b32 v19, 16, v19
    v_mul_f32 v16, v19, v17
    s_nop 1
    v_mov_b32_dpp v17, v16 quad_perm:[1,0,3,2] row_mask:0xf bank_mask:0xf
    v_cvt_pk_bf16_f32 v16, v16, v17
    s_mov_b32 exec_lo, 0x55555555
    s_mov_b32 exec_hi, 0x55555555
    buffer_store_dword v16, v76, s[52:55], s14 offen sc1
    s_mov_b64 exec, -1
    s_branch L_done
L_stD:
    s_mov_b32 s72, s34
    s_and_b32 s73, s35, 0xffff
    s_mov_b32 s74, 1024
    s_mov_b32 s75, 0x20000
    s_mul_i32 s10, s3, 448
    s_add_u32 s10, s10, 139264
    s_lshl_b32 s11, s9, 7
    s_add_u32 s11, s11, 142912
    v_mov_b32 v4, s10
    v_mov_b32 v5, s11
    v_cmp_gt_u32 vcc, 28, v1
    s_nop 1
    v_cndmask_b32 v4, v5, v4, vcc
    v_add_u32 v4, v4, v2
    v_and_b32 v5, 31, v1
    v_lshlrev_b32 v5, 2, v5
    s_lshl_b32 s13, s3, 7
    v_add_u32 v6, s13, v3
    v_lshrrev_b32 v7, 1, v5
    s_lshl_b32 s14, s9, 6
    s_lshl_b32 s13, s3, 10
    s_add_u32 s13, s13, 4096
    v_add_u32 v72, s13, v2
    v_add_u32 v73, s13, v3
    v_add_u32 v74, s13, v5
    s_mov_b32 exec_hi, 0xf
    s_mov_b32 s56, 1
    s_mov_b32 s57, 20000
L_poll_5:
    buffer_load_dwordx4 v[16:19], v4, s[52:55], 0 offen sc1
    s_sub_u32 s57, s57, 1
    s_cmp_eq_u32 s57, 0
    s_waitcnt vmcnt(0)
    s_cbranch_scc1 L_poll_5_done
    v_max3_u32 v78, v16, v17, v18
    v_max_u32 v78, v78, v19
    v_cmp_eq_u32 vcc, -1, v78
    s_nop 0
    s_cbranch_vccz L_poll_5_done
    s_sleep 1
    s_branch L_poll_5
    s_nop 0
L_poll_5_done:
    ds_write_b128 v72, v[16:19]
    s_mov_b64 exec, -1
    s_waitcnt lgkmcnt(0)
    ds_read_b128 v[32:35], v73 offset:0
    ds_read_b128 v[36:39], v73 offset:64
    ds_read_b128 v[40:43], v73 offset:128
    ds_read_b128 v[44:47], v73 offset:192
    ds_read_b128 v[48:51], v73 offset:256
    ds_read_b128 v[52:55], v73 offset:320
    ds_read_b128 v[56:59], v73 offset:384
    ds_read_b32 v20, v74 offset:448
    s_waitcnt lgkmcnt(7)
    v_mfma_f32_16x16x32_bf16 v[8:11], v[188:191], v[32:35], 0
    v_mfma_f32_16x16x32_bf16 v[12:15], v[216:219], v[32:35], 0
    s_waitcnt lgkmcnt(6)
    v_mfma_f32_16x16x32_bf16 v[8:11], v[192:195], v[36:39], v[8:11]
    v_mfma_f32_16x16x32_bf16 v[12:15], v[220:223], v[36:39], v[12:15]
    s_waitcnt lgkmcnt(5)
    v_mfma_f32_16x16x32_bf16 v[8:11], v[196:199], v[40:43], v[8:11]
    v_mfma_f32_16x16x32_bf16 v[12:15], v[224:227], v[40:43], v[12:15]
    s_waitcnt lgkmcnt(4)
    v_mfma_f32_16x16x32_bf16 v[8:11], v[200:203], v[44:47], v[8:11]
    v_mfma_f32_16x16x32_bf16 v[12:15], v[228:231], v[44:47], v[12:15]
    s_waitcnt lgkmcnt(3)
    v_mfma_f32_16x16x32_bf16 v[8:11], v[204:207], v[48:51], v[8:11]
    v_mfma_f32_16x16x32_bf16 v[12:15], v[232:235], v[48:51], v[12:15]
    s_waitcnt lgkmcnt(2)
    v_mfma_f32_16x16x32_bf16 v[8:11], v[208:211], v[52:55], v[8:11]
    v_mfma_f32_16x16x32_bf16 v[12:15], v[236:239], v[52:55], v[12:15]
    s_waitcnt lgkmcnt(1)
    v_mfma_f32_16x16x32_bf16 v[8:11], v[212:215], v[56:59], v[8:11]
    v_mfma_f32_16x16x32_bf16 v[12:15], v[240:243], v[56:59], v[12:15]
    s_nop 6
    ds_write_b128 v6, v[8:11]
    ds_write_b128 v6, v[12:15] offset:64
    s_waitcnt lgkmcnt(0)
    s_barrier
    s_cmp_lg_u32 s3, 0
    s_cbranch_scc1 L_done
    ds_read_b32 v8, v5 offset:0
    ds_read_b32 v9, v5 offset:128
    ds_read_b32 v10, v5 offset:256
    ds_read_b32 v11, v5 offset:384
    ds_read_b32 v12, v5 offset:512
    ds_read_b32 v13, v5 offset:640
    ds_read_b32 v14, v5 offset:768
    ds_read_b32 v15, v5 offset:896
    s_waitcnt lgkmcnt(0)
    v_add_f32 v8, v8, v9
    v_add_f32 v10, v10, v11
    v_add_f32 v12, v12, v13
    v_add_f32 v14, v14, v15
    v_add_f32 v8, v8, v10
    v_add_f32 v12, v12, v14
    v_add_f32 v8, v8, v12
    v_cvt_pk_bf16_f32 v8, v8, v8
    v_lshlrev_b32 v8, 16, v8
    v_add_f32 v8, v8, v20
    s_nop 1
    v_mov_b32_dpp v9, v8 quad_perm:[1,0,3,2] row_mask:0xf bank_mask:0xf
    v_cvt_pk_bf16_f32 v8, v8, v9
    s_mov_b64 exec, 0x55555555
    buffer_store_dword v8, v7, s[72:75], s14 offen
    s_cmp_lg_u32 s9, 0
    s_cbranch_scc1 L_noepoch
    s_mov_b64 exec, 1
    v_mov_b32 v12, s15
    v_mov_b32 v13, 0
    s_mov_b32 s10, 0
    buffer_store_dword v12, v13, s[52:55], s10 offen
L_noepoch:
    s_mov_b64 exec, -1
    s_branch L_done
L_done:
    s_endpgm
.section .rodata,"a"
.p2align 6
.amdhsa_kernel sequential_preLN__gqa_block_cached__glu_gated_glu__decode_kernel
  .amdhsa_next_free_vgpr 256
  .amdhsa_next_free_sgpr 92
  .amdhsa_accum_offset 256
  .amdhsa_group_segment_fixed_size 0
  .amdhsa_kernarg_size 96
  .amdhsa_user_sgpr_count 2
  .amdhsa_user_sgpr_kernarg_segment_ptr 1
  .amdhsa_system_sgpr_workgroup_id_x 1
.end_amdhsa_kernel
```
